```python
import torch

def _softmax(x, axis=-1):
    return torch.softmax(x, dim=axis)

def _gelu(x):
    return torch.nn.functional.gelu(x, approximate='tanh')

def _silu(x):
    return torch.nn.functional.silu(x)

def _sigmoid(x):
    return torch.sigmoid(x)

def _layernorm(x, axis=-1, eps=1e-05):
    m = x.mean(dim=axis, keepdim=True)
    v = x.var(dim=axis, keepdim=True, unbiased=False)
    return (x - m) / torch.sqrt(v + eps)

def _scatter_add(tgt, idx, src, axis=0):
    return tgt.clone().index_add_(axis, idx, src)

def _segment_sum(src, seg, n):
    out = torch.zeros((n,) + src.shape[1:], dtype=src.dtype)
    return out.index_add_(0, seg, src)

def _pad(x, pw):
    flat = tuple((v for pair in reversed(pw) for v in pair))
    return torch.nn.functional.pad(x, flat)
kernel_name = 'gather_scatter__tensor_product_equiv_equiformer__graph'

def setup_inputs():

    _w = lambda a: (lambda t: t.to(torch.bfloat16) if t.is_floating_point() else t)(torch.as_tensor(a))
    N, deg, C, De = (50000, 16, 64, max(16, 1))
    E = N * deg
    src = (lambda lo, hi, *s: torch.randint(lo, hi, s))(0, N, E).to(torch.int64)
    dst = (lambda lo, hi, *s: torch.randint(lo, hi, s))(0, N, E).to(torch.int64)
    rvec = (lambda *s: torch.randn(*s, dtype=torch.bfloat16) * 0.05)(E, 3).to(float)
    rn = (torch.linalg.norm(rvec, dim=-1, keepdim=True) + 1e-06).to(float)
    rhat = (rvec / rn).to(float)
    eps = torch.zeros((3, 3, 3), dtype=float)
    eps[0, 1, 2] = eps[1, 2, 0] = eps[2, 0, 1] = 1.0
    eps[0, 2, 1] = eps[2, 1, 0] = eps[1, 0, 2] = -1.0
    return {'x': _w((lambda *s: torch.randn(*s, dtype=torch.bfloat16) * 0.2)(N, 4 * C).to(float)), 'rhat': _w(rhat), 'e_attr': _w((lambda *s: torch.randn(*s, dtype=torch.bfloat16) * 0.2)(E, De).to(float)), 'src': _w(src), 'dst': _w(dst), 'w_rad': _w((lambda *s: torch.randn(*s, dtype=torch.bfloat16) * 0.2)(De, 5 * C).to(float)), 'w_si0': _w((lambda *s: torch.randn(*s, dtype=torch.bfloat16) * 0.2)(2 * C, C).to(float)), 'w_si1': _w((lambda *s: torch.randn(*s, dtype=torch.bfloat16) * 0.05)(3 * C, C).to(float)), 'cg_eps': _w(eps)}

def reference(x, rhat, e_attr, src, dst, w_rad, w_si0, w_si1, cg_eps):
    N = x.shape[0]
    C = w_si0.shape[1]
    E = rhat.shape[0]
    x0 = x[:, :C].clone()
    x1 = x[:, C:].reshape(N, 3, C)
    R = (e_attr @ w_rad).reshape(E, 5, C)
    f0 = x0[src]
    f1 = x1[src]
    Y1 = rhat
    p00_0 = f0 * R[:, 0, :]
    p11_0 = torch.einsum('ejc,ej->ec', f1, Y1) * R[:, 1, :]
    p01_1 = torch.einsum('ec,ej->ejc', f0, Y1) * R[:, 2, :][:, None, :]
    p10_1 = f1 * R[:, 3, :][:, None, :]
    p11_1 = torch.einsum('ijk,ekc,ej->eic', cg_eps, f1, Y1) * R[:, 4, :][:, None, :]
    m0 = torch.concatenate([p00_0, p11_0], axis=-1) @ w_si0
    m1 = torch.einsum('ejp,pc->ejc', torch.concatenate([p01_1, p10_1, p11_1], axis=-1), w_si1)
    agg0 = _segment_sum(m0, dst, N)
    agg1 = _segment_sum(m1.reshape(E, 3 * C), dst, N).reshape(N, 3, C)
    gate = _sigmoid(agg0)
    out1 = agg1 * gate[:, None, :]
    return torch.concatenate([agg0, out1.reshape(N, 3 * C)], axis=-1)
```

```asm
; @launch kernel=k1_sort_kernel grid=(239,1,1) block=(896,1,1) lds=59392
; @launch kernel=gather_scatter__tensor_product_equiv_equiformer__graph_kernel grid=(256,1,1) block=(512,1,1) lds=156672
.amdgcn_target "amdgcn-amd-amdhsa--gfx950"
.text
.globl k1_sort_kernel
.p2align 8
.type k1_sort_kernel,@function
k1_sort_kernel:
	s_cmp_ge_u32 s2, 224
	s_cbranch_scc1 K1_prep
	s_load_dwordx2 s[12:13], s[0:1], 8
	s_load_dwordx2 s[8:9], s[0:1], 24
	s_load_dwordx2 s[4:5], s[0:1], 32
	s_load_dwordx2 s[16:17], s[0:1], 88
	v_lshlrev_b32 v1, 2, v0
	v_mov_b32 v2, 0
	v_cmp_gt_u32 vcc, 256, v0
	s_nop 0
	s_and_saveexec_b64 s[26:27], vcc
	s_cbranch_execz K1_z
	ds_write_b32 v1, v2
K1_z:
	s_mov_b64 exec, s[26:27]
	s_mul_i32 s3, s2, 3584
	v_add_u32 v3, s3, v1
	v_lshlrev_b32 v4, 2, v3
	v_mul_u32_u24 v5, 6, v3
	s_mov_b32 s20, 800000
	s_mov_b32 s21, 85599
	s_mov_b32 s22, 0xffff0000
	s_waitcnt lgkmcnt(0)
	s_and_b32 s5, s5, 0xffff
	s_mov_b32 s6, 3200000
	s_mov_b32 s7, 0x20000
	s_and_b32 s9, s9, 0xffff
	s_mov_b32 s10, 3200000
	s_mov_b32 s11, 0x20000
	s_and_b32 s13, s13, 0xffff
	s_mov_b32 s14, 4800000
	s_mov_b32 s15, 0x20000
	s_and_b32 s17, s17, 0xffff
	s_mov_b32 s18, 10092544
	s_mov_b32 s19, 0x20000
	v_cmp_gt_u32 vcc, s20, v3
	s_nop 0
	s_and_saveexec_b64 s[26:27], vcc
	s_mov_b64 s[28:29], exec
	s_cbranch_execz K1_a
	buffer_load_dwordx4 v[8:11], v4, s[4:7], 0 offen
	buffer_load_dwordx4 v[12:15], v4, s[8:11], 0 offen
	buffer_load_dwordx4 v[16:19], v5, s[12:15], 0 offen
	buffer_load_dwordx2 v[20:21], v5, s[12:15], 0 offen offset:16
K1_a:
	s_mov_b64 exec, s[26:27]
	s_waitcnt lgkmcnt(0)
	s_barrier
	s_mov_b64 exec, s[28:29]
	s_cbranch_execz K1_b
	v_mov_b32 v6, 1
	s_waitcnt vmcnt(3)
	v_mul_u32_u24 v24, s21, v8
	v_mul_u32_u24 v25, s21, v9
	v_mul_u32_u24 v26, s21, v10
	v_mul_u32_u24 v27, s21, v11
	v_lshrrev_b32 v24, 24, v24
	v_lshrrev_b32 v25, 24, v25
	v_lshrrev_b32 v26, 24, v26
	v_lshrrev_b32 v27, 24, v27
	v_mul_u32_u24 v28, 196, v24
	v_lshlrev_b32 v24, 2, v24
	v_mul_u32_u24 v29, 196, v25
	v_lshlrev_b32 v25, 2, v25
	v_mul_u32_u24 v30, 196, v26
	v_lshlrev_b32 v26, 2, v26
	v_mul_u32_u24 v31, 196, v27
	v_lshlrev_b32 v27, 2, v27
	ds_add_rtn_u32 v35, v24, v6
	ds_add_rtn_u32 v39, v25, v6
	ds_add_rtn_u32 v43, v26, v6
	ds_add_rtn_u32 v47, v27, v6
	v_sub_u32 v28, v8, v28
	v_add_u32 v7, 0, v3
	v_lshl_or_b32 v34, v28, 24, v7
	v_sub_u32 v29, v9, v29
	v_add_u32 v7, 1, v3
	v_lshl_or_b32 v38, v29, 24, v7
	v_sub_u32 v30, v10, v30
	v_add_u32 v7, 2, v3
	v_lshl_or_b32 v42, v30, 24, v7
	v_sub_u32 v31, v11, v31
	v_add_u32 v7, 3, v3
	v_lshl_or_b32 v46, v31, 24, v7
K1_b:
	s_mov_b64 exec, s[26:27]
	s_waitcnt lgkmcnt(0)
	s_barrier
	v_and_b32 v48, 63, v0
	v_lshlrev_b32 v48, 4, v48
	ds_read_b128 v[52:55], v48
	s_waitcnt lgkmcnt(0)
	v_add_u32 v56, v52, v53
	v_add_u32 v57, v56, v54
	v_add_u32 v58, v57, v55
	v_mov_b32 v59, v58
	s_nop 1
	v_add_u32_dpp v59, v59, v59 row_shr:1 row_mask:0xf bank_mask:0xf bound_ctrl:1
	s_nop 1
	v_add_u32_dpp v59, v59, v59 row_shr:2 row_mask:0xf bank_mask:0xf bound_ctrl:1
	s_nop 1
	v_add_u32_dpp v59, v59, v59 row_shr:4 row_mask:0xf bank_mask:0xf bound_ctrl:1
	s_nop 1
	v_add_u32_dpp v59, v59, v59 row_shr:8 row_mask:0xf bank_mask:0xf bound_ctrl:1
	s_nop 1
	v_add_u32_dpp v59, v59, v59 row_bcast:15 row_mask:0xa bank_mask:0xf
	s_nop 1
	v_add_u32_dpp v59, v59, v59 row_bcast:31 row_mask:0xc bank_mask:0xf
	v_sub_u32 v60, v59, v58
	v_add_u32 v61, v60, v52
	v_add_u32 v62, v60, v56
	v_add_u32 v63, v60, v57
	ds_write_b128 v48, v[60:63] offset:1024
	v_cmp_gt_u32 vcc, 64, v0
	s_nop 0
	s_and_saveexec_b64 s[30:31], vcc
	s_cbranch_execz K1_t
	v_lshl_or_b32 v64, v52, 16, v60
	v_lshl_or_b32 v65, v53, 16, v61
	v_lshl_or_b32 v66, v54, 16, v62
	v_lshl_or_b32 v67, v55, 16, v63
	s_lshl_b32 s23, s2, 10
	s_add_u32 s23, s23, 9699328
	buffer_store_dwordx4 v[64:67], v48, s[16:19], s23 offen sc0 sc1
K1_t:
	s_mov_b64 exec, s[28:29]
	s_cbranch_execz K1_w
	ds_read_b32 v8, v24 offset:1024
	ds_read_b32 v9, v25 offset:1024
	ds_read_b32 v10, v26 offset:1024
	ds_read_b32 v11, v27 offset:1024
	s_waitcnt vmcnt(0)
	v_lshl_or_b32 v32, v16, 16, v12
	v_alignbit_b32 v33, v17, v16, 16
	v_and_or_b32 v36, v17, s22, v13
	v_mov_b32 v37, v18
	v_lshl_or_b32 v40, v19, 16, v14
	v_alignbit_b32 v41, v20, v19, 16
	v_and_or_b32 v44, v20, s22, v15
	v_mov_b32 v45, v21
	s_waitcnt lgkmcnt(3)
	s_waitcnt lgkmcnt(0)
	v_add_u32 v8, v8, v35
	v_lshlrev_b32 v8, 4, v8
	ds_write_b96 v8, v[32:34] offset:2048
	v_add_u32 v9, v9, v39
	v_lshlrev_b32 v9, 4, v9
	ds_write_b96 v9, v[36:38] offset:2048
	v_add_u32 v10, v10, v43
	v_lshlrev_b32 v10, 4, v10
	ds_write_b96 v10, v[40:42] offset:2048
	v_add_u32 v11, v11, v47
	v_lshlrev_b32 v11, 4, v11
	ds_write_b96 v11, v[44:46] offset:2048
K1_w:
	s_mov_b64 exec, -1
	s_waitcnt lgkmcnt(0)
	s_barrier
	v_lshlrev_b32 v8, 4, v0
	ds_read_b96 v[32:34], v8 offset:2048
	ds_read_b96 v[36:38], v8 offset:16384
	ds_read_b96 v[40:42], v8 offset:30720
	ds_read_b96 v[44:46], v8 offset:45056
	v_mul_u32_u24 v9, 12, v0
	s_mul_i32 s32, s2, 43008
	s_mul_i32 s33, s2, 43008
	s_add_u32 s33, s33, 10752
	s_mul_i32 s34, s2, 43008
	s_add_u32 s34, s34, 21504
	s_mul_i32 s35, s2, 43008
	s_add_u32 s35, s35, 32256
	s_waitcnt lgkmcnt(3)
	buffer_store_dwordx3 v[32:34], v9, s[16:19], s32 offen sc0 sc1
	s_waitcnt lgkmcnt(2)
	buffer_store_dwordx3 v[36:38], v9, s[16:19], s33 offen sc0 sc1
	s_waitcnt lgkmcnt(1)
	buffer_store_dwordx3 v[40:42], v9, s[16:19], s34 offen sc0 sc1
	s_waitcnt lgkmcnt(0)
	buffer_store_dwordx3 v[44:46], v9, s[16:19], s35 offen sc0 sc1
K1_done:
	s_endpgm
K1_prep:
	s_sub_u32 s3, s2, 224
	s_cmp_ge_u32 s3, 15
	s_cbranch_scc1 K1_done2
	s_load_dwordx2 s[4:5], s[0:1], 40
	s_load_dwordx4 s[20:23], s[0:1], 48
	s_load_dwordx2 s[16:17], s[0:1], 88
	s_mul_i32 s3, s3, 896
	v_add_u32 v1, s3, v0
	s_nop 0
	v_readfirstlane_b32 s24, v1
	s_nop 0
	s_cmp_ge_u32 s24, 12800
	s_cbranch_scc1 K1_done2
	s_lshr_b32 s24, s24, 8
	v_lshrrev_b32 v2, 2, v1
	v_and_b32 v2, 63, v2
	v_and_b32 v3, 3, v1
	v_and_b32 v4, 15, v2
	v_lshrrev_b32 v5, 4, v2
	s_waitcnt lgkmcnt(0)
	s_and_b32 s17, s17, 0xffff
	s_mov_b32 s18, 10092544
	s_mov_b32 s19, 0x20000
	s_cmp_ge_u32 s24, 10
	s_cbranch_scc1 K1_pw
	s_and_b32 s5, s5, 0xffff
	s_mov_b32 s6, 10240
	s_mov_b32 s7, 0x20000
	s_lshr_b32 s25, s24, 1
	s_and_b32 s26, s24, 1
	s_lshl_b32 s25, s25, 6
	s_lshl_b32 s26, s26, 1
	s_add_u32 s25, s25, s26
	v_lshlrev_b32 v6, 2, v4
	v_lshrrev_b32 v7, 1, v5
	v_add3_u32 v6, v6, v7, s25
	v_and_b32 v7, 1, v5
	v_lshlrev_b32 v7, 3, v7
	v_lshl_add_u32 v7, v3, 1, v7
	v_mul_u32_u24 v7, 320, v7
	v_add_lshl_u32 v6, v6, v7, 1
	buffer_load_ushort v8, v6, s[4:7], 0 offen
	buffer_load_ushort v9, v6, s[4:7], 0 offen offset:640
	s_branch K1_pst
K1_pw:
	s_sub_u32 s25, s24, 10
	s_cmp_ge_u32 s25, 16
	s_cbranch_scc1 K1_pw1
	s_mov_b32 s4, s20
	s_mov_b32 s5, s21
	s_and_b32 s5, s5, 0xffff
	s_mov_b32 s6, 16384
	s_mov_b32 s7, 0x20000
	s_branch K1_pw2
K1_pw1:
	s_sub_u32 s25, s25, 16
	s_mov_b32 s4, s22
	s_mov_b32 s5, s23
	s_and_b32 s5, s5, 0xffff
	s_mov_b32 s6, 24576
	s_mov_b32 s7, 0x20000
K1_pw2:
	s_lshr_b32 s26, s25, 2
	s_and_b32 s27, s25, 3
	s_lshl_b32 s26, s26, 5
	s_lshl_b32 s27, s27, 2
	v_lshrrev_b32 v6, 2, v4
	v_lshlrev_b32 v6, 4, v6
	v_and_b32 v7, 3, v4
	v_add3_u32 v6, v6, v7, s27
	v_lshlrev_b32 v7, 3, v5
	v_lshl_add_u32 v7, v3, 1, v7
	v_add_u32 v7, s26, v7
	v_lshlrev_b32 v7, 6, v7
	v_add_lshl_u32 v6, v6, v7, 1
	buffer_load_ushort v8, v6, s[4:7], 0 offen
	buffer_load_ushort v9, v6, s[4:7], 0 offen offset:128
K1_pst:
	v_lshlrev_b32 v1, 2, v1
	s_mov_b32 s28, 9961472
	s_waitcnt vmcnt(0)
	v_lshl_or_b32 v8, v9, 16, v8
	buffer_store_dword v8, v1, s[16:19], s28 offen
K1_done2:
	s_endpgm
.globl gather_scatter__tensor_product_equiv_equiformer__graph_kernel
.p2align 8
.type gather_scatter__tensor_product_equiv_equiformer__graph_kernel,@function
gather_scatter__tensor_product_equiv_equiformer__graph_kernel:
	s_cmp_ge_u32 s2, 256
	s_cbranch_scc1 K2_end
	s_and_b32 s3, s2, 7
	s_lshl_b32 s3, s3, 5
	s_lshr_b32 s2, s2, 3
	s_add_u32 s2, s2, s3
	s_load_dwordx2 s[4:5], s[0:1], 0
	s_load_dwordx2 s[8:9], s[0:1], 16
	s_load_dwordx2 s[12:13], s[0:1], 72
	s_load_dwordx2 s[16:17], s[0:1], 88
	v_mov_b32 v247, v0
	v_and_b32 v246, 63, v0
	v_lshrrev_b32 v248, 6, v0
	v_lshlrev_b32 v249, 2, v0
	v_readfirstlane_b32 s20, v248
	v_mov_b32 v200, 0
	v_cmp_gt_u32 vcc, 336, v247
	s_nop 0
	s_and_saveexec_b64 s[38:39], vcc
	s_cbranch_execz K2_z
	ds_write_b32 v249, v200
K2_z:
	s_mov_b64 exec, s[38:39]
	v_mov_b32 v200, 0xffff
	v_mov_b32 v201, 0
	v_mov_b32 v202, 0xffff
	v_mov_b32 v203, 0
	v_mov_b32 v204, 2.0
	v_mov_b32 v205, 2.0
	v_mov_b32 v206, 2.0
	v_mov_b32 v207, 2.0
	v_lshlrev_b32 v250, 4, v247
	ds_write_b128 v250, v[200:203] offset:4096
	ds_write_b128 v250, v[200:203] offset:12288
	ds_write_b128 v250, v[200:203] offset:20480
	ds_write_b128 v250, v[200:203] offset:28672
	ds_write_b128 v250, v[204:207] offset:36864
	ds_write_b128 v250, v[204:207] offset:45056
	v_lshrrev_b32 v251, 4, v247
	s_lshl_b32 s3, s2, 2
	v_lshl_add_u32 v252, v251, 10, s3
	v_lshlrev_b32 v253, 4, v246
	s_waitcnt lgkmcnt(0)
	s_and_b32 s5, s5, 0xffff
	s_mov_b32 s6, 25600000
	s_mov_b32 s7, 0x20000
	s_and_b32 s9, s9, 0xffff
	s_mov_b32 s10, 25600000
	s_mov_b32 s11, 0x20000
	s_and_b32 s13, s13, 0xffff
	s_mov_b32 s14, 25600000
	s_mov_b32 s15, 0x20000
	s_and_b32 s17, s17, 0xffff
	s_mov_b32 s18, 10092544
	s_mov_b32 s19, 0x20000
	s_mov_b32 s84, 9699328
	s_mov_b32 s85, 9732096
	s_mov_b32 s86, 9764864
	s_mov_b32 s87, 9797632
	s_mov_b32 s88, 9830400
	s_mov_b32 s89, 9863168
	s_mov_b32 s90, 9895936
	buffer_load_dword v124, v252, s[16:19], s84 offen
	buffer_load_dword v125, v252, s[16:19], s85 offen
	buffer_load_dword v126, v252, s[16:19], s86 offen
	buffer_load_dword v127, v252, s[16:19], s87 offen
	buffer_load_dword v128, v252, s[16:19], s88 offen
	buffer_load_dword v129, v252, s[16:19], s89 offen
	buffer_load_dword v130, v252, s[16:19], s90 offen
	v_and_b32 v208, 15, v246
	v_lshrrev_b32 v209, 4, v246
	v_lshlrev_b32 v228, 3, v208
	v_lshrrev_b32 v210, 1, v209
	v_and_b32 v211, 1, v208
	v_cmp_eq_u32 vcc, v210, v211
	v_and_b32 v212, 1, v209
	v_lshlrev_b32 v212, 4, v212
	v_mov_b32 v213, 2.0
	v_cndmask_b32 v229, v213, v212, vcc
	v_lshlrev_b32 v230, 4, v209
	v_add_u32 v230, 4096, v230
	v_lshrrev_b32 v231, 1, v208
	v_lshlrev_b32 v231, 2, v231
	v_add_u32 v231, 36864, v231
	s_mul_i32 s30, s20, 5760
	s_add_u32 s30, s30, 94208
	v_mul_u32_u24 v239, 1440, v209
	v_add3_u32 v239, v239, v228, s30
	v_lshrrev_b32 v210, 2, v208
	v_mul_u32_u24 v240, 1440, v210
	v_lshlrev_b32 v211, 4, v209
	v_add3_u32 v240, v240, v211, s30
	v_and_b32 v211, 3, v208
	v_min_u32 v212, 2, v211
	v_mul_u32_u24 v212, 384, v212
	v_add_u32 v212, 256, v212
	v_add_u32 v241, v240, v212
	v_lshlrev_b32 v242, 4, v246
	v_add_u32 v242, 53248, v242
	v_lshlrev_b32 v212, 5, v209
	v_lshl_add_u32 v243, v211, 3, v212
	v_lshl_add_u32 v244, v211, 7, v212
	v_add_u32 v244, 128, v244
	v_cmp_eq_u32 vcc, 3, v211
	s_nop 1
	v_cndmask_b32 v244, v244, v213, vcc
	v_lshlrev_b32 v245, 2, v210
	v_add_u32 v245, 2048, v245
	s_mov_b32 s26, 512
	s_mov_b32 s27, 0xffff0000
	s_mul_i32 s30, s2, 100352
	s_mov_b32 s32, 572662306
	s_mov_b32 s33, 572662306
	s_mov_b32 s34, 1145324612
	s_mov_b32 s35, 1145324612
	s_mov_b32 s36, 2290649224
	s_mov_b32 s37, 2290649224
	v_and_b32 v152, 15, v247
	v_mul_u32_u24 v153, 43008, v251
	v_add_u32 v168, 16, v152
	v_add_u32 v169, 32, v152
	s_mov_b64 s[82:83], 0
	s_mov_b32 s84, 0
	s_mov_b32 s85, 1376256
	s_mov_b32 s86, 2752512
	s_mov_b32 s87, 4128768
	s_mov_b32 s88, 5505024
	s_mov_b32 s89, 6881280
	s_mov_b32 s90, 8257536
	s_waitcnt vmcnt(0)
	v_lshrrev_b32 v154, 16, v124
	v_and_b32 v161, 0xffff, v124
	v_add_u32 v161, v161, v152
	v_mad_u32_u24 v161, v161, 12, v153
	v_cmp_gt_u32 s[40:41], v154, v152
	v_cmp_gt_u32 s[54:55], v154, v168
	v_cmp_gt_u32 s[68:69], v154, v169
	v_cmp_lt_u32 vcc, 48, v154
	s_nop 0
	s_or_b64 s[82:83], s[82:83], vcc
	v_lshrrev_b32 v155, 16, v125
	v_and_b32 v162, 0xffff, v125
	v_add_u32 v162, v162, v152
	v_mad_u32_u24 v162, v162, 12, v153
	v_cmp_gt_u32 s[42:43], v155, v152
	v_cmp_gt_u32 s[56:57], v155, v168
	v_cmp_gt_u32 s[70:71], v155, v169
	v_cmp_lt_u32 vcc, 48, v155
	s_nop 0
	s_or_b64 s[82:83], s[82:83], vcc
	v_lshrrev_b32 v156, 16, v126
	v_and_b32 v163, 0xffff, v126
	v_add_u32 v163, v163, v152
	v_mad_u32_u24 v163, v163, 12, v153
	v_cmp_gt_u32 s[44:45], v156, v152
	v_cmp_gt_u32 s[58:59], v156, v168
	v_cmp_gt_u32 s[72:73], v156, v169
	v_cmp_lt_u32 vcc, 48, v156
	s_nop 0
	s_or_b64 s[82:83], s[82:83], vcc
	v_lshrrev_b32 v157, 16, v127
	v_and_b32 v164, 0xffff, v127
	v_add_u32 v164, v164, v152
	v_mad_u32_u24 v164, v164, 12, v153
	v_cmp_gt_u32 s[46:47], v157, v152
	v_cmp_gt_u32 s[60:61], v157, v168
	v_cmp_gt_u32 s[74:75], v157, v169
	v_cmp_lt_u32 vcc, 48, v157
	s_nop 0
	s_or_b64 s[82:83], s[82:83], vcc
	v_lshrrev_b32 v158, 16, v128
	v_and_b32 v165, 0xffff, v128
	v_add_u32 v165, v165, v152
	v_mad_u32_u24 v165, v165, 12, v153
	v_cmp_gt_u32 s[48:49], v158, v152
	v_cmp_gt_u32 s[62:63], v158, v168
	v_cmp_gt_u32 s[76:77], v158, v169
	v_cmp_lt_u32 vcc, 48, v158
	s_nop 0
	s_or_b64 s[82:83], s[82:83], vcc
	v_lshrrev_b32 v159, 16, v129
	v_and_b32 v166, 0xffff, v129
	v_add_u32 v166, v166, v152
	v_mad_u32_u24 v166, v166, 12, v153
	v_cmp_gt_u32 s[50:51], v159, v152
	v_cmp_gt_u32 s[64:65], v159, v168
	v_cmp_gt_u32 s[78:79], v159, v169
	v_cmp_lt_u32 vcc, 48, v159
	s_nop 0
	s_or_b64 s[82:83], s[82:83], vcc
	v_lshrrev_b32 v160, 16, v130
	v_and_b32 v167, 0xffff, v130
	v_add_u32 v167, v167, v152
	v_mad_u32_u24 v167, v167, 12, v153
	v_cmp_gt_u32 s[52:53], v160, v152
	v_cmp_gt_u32 s[66:67], v160, v168
	v_cmp_gt_u32 s[80:81], v160, v169
	v_cmp_lt_u32 vcc, 48, v160
	s_nop 0
	s_or_b64 s[82:83], s[82:83], vcc
	s_mov_b64 exec, s[40:41]
	buffer_load_dwordx3 v[0:2], v161, s[16:19], s84 offen offset:0
	s_mov_b64 exec, s[42:43]
	buffer_load_dwordx3 v[4:6], v162, s[16:19], s85 offen offset:0
	s_mov_b64 exec, s[44:45]
	buffer_load_dwordx3 v[8:10], v163, s[16:19], s86 offen offset:0
	s_mov_b64 exec, s[46:47]
	buffer_load_dwordx3 v[12:14], v164, s[16:19], s87 offen offset:0
	s_mov_b64 exec, s[48:49]
	buffer_load_dwordx3 v[16:18], v165, s[16:19], s88 offen offset:0
	s_mov_b64 exec, s[50:51]
	buffer_load_dwordx3 v[20:22], v166, s[16:19], s89 offen offset:0
	s_mov_b64 exec, s[52:53]
	buffer_load_dwordx3 v[24:26], v167, s[16:19], s90 offen offset:0
	s_mov_b64 exec, -1
	s_mov_b64 exec, s[54:55]
	buffer_load_dwordx3 v[28:30], v161, s[16:19], s84 offen offset:192
	s_mov_b64 exec, s[56:57]
	buffer_load_dwordx3 v[32:34], v162, s[16:19], s85 offen offset:192
	s_mov_b64 exec, s[58:59]
	buffer_load_dwordx3 v[36:38], v163, s[16:19], s86 offen offset:192
	s_mov_b64 exec, s[60:61]
	buffer_load_dwordx3 v[40:42], v164, s[16:19], s87 offen offset:192
	s_mov_b64 exec, s[62:63]
	buffer_load_dwordx3 v[44:46], v165, s[16:19], s88 offen offset:192
	s_mov_b64 exec, s[64:65]
	buffer_load_dwordx3 v[48:50], v166, s[16:19], s89 offen offset:192
	s_mov_b64 exec, s[66:67]
	buffer_load_dwordx3 v[52:54], v167, s[16:19], s90 offen offset:192
	s_mov_b64 exec, -1
	s_mov_b64 s[96:97], 0
	s_or_b64 s[96:97], s[96:97], s[68:69]
	s_or_b64 s[96:97], s[96:97], s[70:71]
	s_or_b64 s[96:97], s[96:97], s[72:73]
	s_or_b64 s[96:97], s[96:97], s[74:75]
	s_or_b64 s[96:97], s[96:97], s[76:77]
	s_or_b64 s[96:97], s[96:97], s[78:79]
	s_or_b64 s[96:97], s[96:97], s[80:81]
	s_cbranch_scc0 K2_nb2a
	s_mov_b64 exec, s[68:69]
	buffer_load_dwordx3 v[56:58], v161, s[16:19], s84 offen offset:384
	s_mov_b64 exec, s[70:71]
	buffer_load_dwordx3 v[60:62], v162, s[16:19], s85 offen offset:384
	s_mov_b64 exec, s[72:73]
	buffer_load_dwordx3 v[64:66], v163, s[16:19], s86 offen offset:384
	s_mov_b64 exec, s[74:75]
	buffer_load_dwordx3 v[68:70], v164, s[16:19], s87 offen offset:384
	s_mov_b64 exec, s[76:77]
	buffer_load_dwordx3 v[72:74], v165, s[16:19], s88 offen offset:384
	s_mov_b64 exec, s[78:79]
	buffer_load_dwordx3 v[76:78], v166, s[16:19], s89 offen offset:384
	s_mov_b64 exec, s[80:81]
	buffer_load_dwordx3 v[80:82], v167, s[16:19], s90 offen offset:384
	s_mov_b64 exec, -1
K2_nb2a:
	v_lshlrev_b32 v253, 4, v246
	s_add_u32 s84, s20, 0
	s_lshl_b32 s84, s84, 10
	s_add_u32 s31, s84, 9961472
	buffer_load_dwordx4 v[124:127], v253, s[16:19], s31 offen
	s_add_u32 s85, s20, 8
	s_lshl_b32 s85, s85, 10
	s_add_u32 s31, s85, 9961472
	buffer_load_dwordx4 v[128:131], v253, s[16:19], s31 offen
	s_add_u32 s86, s20, 16
	s_lshl_b32 s86, s86, 10
	s_add_u32 s31, s86, 9961472
	buffer_load_dwordx4 v[132:135], v253, s[16:19], s31 offen
	s_add_u32 s87, s20, 24
	s_lshl_b32 s87, s87, 10
	s_add_u32 s31, s87, 9961472
	buffer_load_dwordx4 v[136:139], v253, s[16:19], s31 offen
	s_add_u32 s88, s20, 32
	s_lshl_b32 s88, s88, 10
	s_add_u32 s31, s88, 9961472
	buffer_load_dwordx4 v[140:143], v253, s[16:19], s31 offen
	s_add_u32 s89, s20, 40
	s_lshl_b32 s89, s89, 10
	s_add_u32 s31, s89, 9961472
	buffer_load_dwordx4 v[144:147], v253, s[16:19], s31 offen
	s_add_u32 s90, s20, 48
	s_min_u32 s90, s90, 49
	s_lshl_b32 s90, s90, 10
	s_add_u32 s31, s90, 9961472
	buffer_load_dwordx4 v[148:151], v253, s[16:19], s31 offen
	s_waitcnt lgkmcnt(0)
	s_barrier
	s_cmp_eq_u64 s[82:83], 0
	s_cbranch_scc1 K2_novf
	v_mov_b32 v248, 1280
	v_mov_b32 v249, 1
	ds_write_b32 v248, v249
K2_novf:
	v_mov_b32 v170, 1
	s_waitcnt vmcnt(7)
	v_cmp_gt_u32 vcc, 512, v247
	s_nop 0
	s_and_b64 exec, vcc, s[40:41]
	v_and_b32 v183, 0xffffff, v2
	v_lshlrev_b32 v183, 5, v183
	buffer_load_dwordx4 v[184:187], v183, s[8:11], 0 offen nt
	buffer_load_dwordx4 v[188:191], v183, s[8:11], 0 offen offset:16 nt
	s_mov_b64 exec, -1
	s_mov_b64 exec, s[40:41]
	v_lshrrev_b32 v200, 22, v2
	v_and_b32 v200, 0x3fc, v200
	ds_add_rtn_u32 v3, v200, v170 offset:0
	s_mov_b64 exec, s[42:43]
	v_lshrrev_b32 v201, 22, v6
	v_and_b32 v201, 0x3fc, v201
	ds_add_rtn_u32 v7, v201, v170 offset:0
	s_mov_b64 exec, s[44:45]
	v_lshrrev_b32 v202, 22, v10
	v_and_b32 v202, 0x3fc, v202
	ds_add_rtn_u32 v11, v202, v170 offset:0
	s_mov_b64 exec, s[46:47]
	v_lshrrev_b32 v203, 22, v14
	v_and_b32 v203, 0x3fc, v203
	ds_add_rtn_u32 v15, v203, v170 offset:0
	s_mov_b64 exec, s[48:49]
	v_lshrrev_b32 v204, 22, v18
	v_and_b32 v204, 0x3fc, v204
	ds_add_rtn_u32 v19, v204, v170 offset:0
	s_mov_b64 exec, s[50:51]
	v_lshrrev_b32 v205, 22, v22
	v_and_b32 v205, 0x3fc, v205
	ds_add_rtn_u32 v23, v205, v170 offset:0
	s_mov_b64 exec, s[52:53]
	v_lshrrev_b32 v206, 22, v26
	v_and_b32 v206, 0x3fc, v206
	ds_add_rtn_u32 v27, v206, v170 offset:0
	s_mov_b64 exec, -1
	s_mov_b64 exec, s[54:55]
	v_lshrrev_b32 v200, 22, v30
	v_and_b32 v200, 0x3fc, v200
	ds_add_rtn_u32 v31, v200, v170 offset:0
	s_mov_b64 exec, s[56:57]
	v_lshrrev_b32 v201, 22, v34
	v_and_b32 v201, 0x3fc, v201
	ds_add_rtn_u32 v35, v201, v170 offset:0
	s_mov_b64 exec, s[58:59]
	v_lshrrev_b32 v202, 22, v38
	v_and_b32 v202, 0x3fc, v202
	ds_add_rtn_u32 v39, v202, v170 offset:0
	s_mov_b64 exec, s[60:61]
	v_lshrrev_b32 v203, 22, v42
	v_and_b32 v203, 0x3fc, v203
	ds_add_rtn_u32 v43, v203, v170 offset:0
	s_mov_b64 exec, s[62:63]
	v_lshrrev_b32 v204, 22, v46
	v_and_b32 v204, 0x3fc, v204
	ds_add_rtn_u32 v47, v204, v170 offset:0
	s_mov_b64 exec, s[64:65]
	v_lshrrev_b32 v205, 22, v50
	v_and_b32 v205, 0x3fc, v205
	ds_add_rtn_u32 v51, v205, v170 offset:0
	s_mov_b64 exec, s[66:67]
	v_lshrrev_b32 v206, 22, v54
	v_and_b32 v206, 0x3fc, v206
	ds_add_rtn_u32 v55, v206, v170 offset:0
	s_mov_b64 exec, -1
	s_cmp_eq_u64 s[96:97], 0
	s_cbranch_scc1 K2_nb2b
	s_mov_b64 exec, s[68:69]
	v_lshrrev_b32 v200, 22, v58
	v_and_b32 v200, 0x3fc, v200
	ds_add_rtn_u32 v59, v200, v170 offset:0
	s_mov_b64 exec, s[70:71]
	v_lshrrev_b32 v201, 22, v62
	v_and_b32 v201, 0x3fc, v201
	ds_add_rtn_u32 v63, v201, v170 offset:0
	s_mov_b64 exec, s[72:73]
	v_lshrrev_b32 v202, 22, v66
	v_and_b32 v202, 0x3fc, v202
	ds_add_rtn_u32 v67, v202, v170 offset:0
	s_mov_b64 exec, s[74:75]
	v_lshrrev_b32 v203, 22, v70
	v_and_b32 v203, 0x3fc, v203
	ds_add_rtn_u32 v71, v203, v170 offset:0
	s_mov_b64 exec, s[76:77]
	v_lshrrev_b32 v204, 22, v74
	v_and_b32 v204, 0x3fc, v204
	ds_add_rtn_u32 v75, v204, v170 offset:0
	s_mov_b64 exec, s[78:79]
	v_lshrrev_b32 v205, 22, v78
	v_and_b32 v205, 0x3fc, v205
	ds_add_rtn_u32 v79, v205, v170 offset:0
	s_mov_b64 exec, s[80:81]
	v_lshrrev_b32 v206, 22, v82
	v_and_b32 v206, 0x3fc, v206
	ds_add_rtn_u32 v83, v206, v170 offset:0
	s_mov_b64 exec, -1
K2_nb2b:
	s_waitcnt lgkmcnt(0)
	s_barrier
	s_waitcnt vmcnt(2)
	v_lshlrev_b32 v253, 4, v246
	s_mov_b32 s92, 94208
	s_mov_b32 s93, 43008
	s_cmp_lt_u32 s84, 10240
	s_cselect_b32 s31, s92, s93
	s_add_u32 s31, s31, s84
	v_add_u32 v254, s31, v253
	ds_write_b128 v254, v[124:127]
	s_cmp_lt_u32 s85, 10240
	s_cselect_b32 s31, s92, s93
	s_add_u32 s31, s31, s85
	v_add_u32 v254, s31, v253
	ds_write_b128 v254, v[128:131]
	s_cmp_lt_u32 s86, 10240
	s_cselect_b32 s31, s92, s93
	s_add_u32 s31, s31, s86
	v_add_u32 v254, s31, v253
	ds_write_b128 v254, v[132:135]
	s_cmp_lt_u32 s87, 10240
	s_cselect_b32 s31, s92, s93
	s_add_u32 s31, s31, s87
	v_add_u32 v254, s31, v253
	ds_write_b128 v254, v[136:139]
	s_cmp_lt_u32 s88, 10240
	s_cselect_b32 s31, s92, s93
	s_add_u32 s31, s31, s88
	v_add_u32 v254, s31, v253
	ds_write_b128 v254, v[140:143]
	s_cmp_lt_u32 s89, 10240
	s_cselect_b32 s31, s92, s93
	s_add_u32 s31, s31, s89
	v_add_u32 v254, s31, v253
	ds_write_b128 v254, v[144:147]
	s_cmp_lt_u32 s90, 10240
	s_cselect_b32 s31, s92, s93
	s_add_u32 s31, s31, s90
	v_add_u32 v254, s31, v253
	ds_write_b128 v254, v[148:151]
	v_mov_b32 v248, 1280
	ds_read_b32 v249, v248
	s_waitcnt lgkmcnt(0)
	v_readfirstlane_b32 s31, v249
	s_nop 0
	s_cmp_lg_u32 s31, 0
	s_cbranch_scc1 K2_slow
	s_cmp_lg_u32 s20, 0
	s_cbranch_scc1 K2_p6
	v_lshlrev_b32 v248, 4, v246
	ds_read_b128 v[152:155], v248 offset:0
	v_cmp_gt_u32 vcc, 49, v246
	s_nop 0
	s_mov_b64 s[84:85], vcc
	v_lshlrev_b32 v249, 2, v246
	v_mov_b32 v156, 0
	v_mov_b32 v160, 0
	v_mov_b32 v157, 0
	v_mov_b32 v161, 0
	v_mov_b32 v158, 0
	v_mov_b32 v162, 0
	v_mov_b32 v159, 0
	v_mov_b32 v163, 0
	s_waitcnt lgkmcnt(0)
	s_mov_b64 exec, s[84:85]
	v_min_u32 v156, 63, v152
	v_sub_u32 v156, 63, v156
	v_lshlrev_b32 v156, 2, v156
	ds_add_rtn_u32 v160, v156, v170 offset:1024
	v_min_u32 v157, 63, v153
	v_sub_u32 v157, 63, v157
	v_lshlrev_b32 v157, 2, v157
	ds_add_rtn_u32 v161, v157, v170 offset:1024
	v_min_u32 v158, 63, v154
	v_sub_u32 v158, 63, v158
	v_lshlrev_b32 v158, 2, v158
	ds_add_rtn_u32 v162, v158, v170 offset:1024
	v_min_u32 v159, 63, v155
	v_sub_u32 v159, 63, v159
	v_lshlrev_b32 v159, 2, v159
	ds_add_rtn_u32 v163, v159, v170 offset:1024
	s_mov_b64 exec, -1
	ds_read_b32 v250, v249 offset:1024
	s_waitcnt lgkmcnt(0)
	v_mov_b32 v251, v250
	s_nop 1
	v_add_u32_dpp v251, v251, v251 row_shr:1 row_mask:0xf bank_mask:0xf bound_ctrl:1
	s_nop 1
	v_add_u32_dpp v251, v251, v251 row_shr:2 row_mask:0xf bank_mask:0xf bound_ctrl:1
	s_nop 1
	v_add_u32_dpp v251, v251, v251 row_shr:4 row_mask:0xf bank_mask:0xf bound_ctrl:1
	s_nop 1
	v_add_u32_dpp v251, v251, v251 row_shr:8 row_mask:0xf bank_mask:0xf bound_ctrl:1
	s_nop 1
	v_add_u32_dpp v251, v251, v251 row_bcast:15 row_mask:0xa bank_mask:0xf
	s_nop 1
	v_add_u32_dpp v251, v251, v251 row_bcast:31 row_mask:0xc bank_mask:0xf
	v_sub_u32 v251, v251, v250
	ds_bpermute_b32 v164, v156, v251
	ds_bpermute_b32 v165, v157, v251
	ds_bpermute_b32 v166, v158, v251
	ds_bpermute_b32 v167, v159, v251
	s_waitcnt lgkmcnt(0)
	s_mov_b64 exec, s[84:85]
	v_add_u32 v164, v164, v160
	v_add_u32 v252, 0, v249
	v_lshl_or_b32 v252, v152, 8, v252
	v_lshlrev_b32 v253, 2, v164
	ds_write_b32 v253, v252 offset:2048
	v_add_u32 v165, v165, v161
	v_add_u32 v252, 1, v249
	v_lshl_or_b32 v252, v153, 8, v252
	v_lshlrev_b32 v253, 2, v165
	ds_write_b32 v253, v252 offset:2048
	v_add_u32 v166, v166, v162
	v_add_u32 v252, 2, v249
	v_lshl_or_b32 v252, v154, 8, v252
	v_lshlrev_b32 v253, 2, v166
	ds_write_b32 v253, v252 offset:2048
	v_add_u32 v167, v167, v163
	v_add_u32 v252, 3, v249
	v_lshl_or_b32 v252, v155, 8, v252
	v_lshlrev_b32 v253, 2, v167
	ds_write_b32 v253, v252 offset:2048
	s_mov_b64 exec, -1
	ds_read_b128 v[168:171], v248 offset:2048
	v_cmp_gt_u32 vcc, 49, v246
	s_waitcnt lgkmcnt(0)
	v_max3_u32 v168, v168, v169, v170
	v_max_u32 v168, v168, v171
	v_lshrrev_b32 v168, 8, v168
	v_add_u32 v168, 1, v168
	v_lshrrev_b32 v168, 1, v168
	v_max_u32 v168, 1, v168
	v_cndmask_b32 v168, 0, v168, vcc
	v_mov_b32 v169, v168
	s_nop 1
	v_add_u32_dpp v169, v169, v169 row_shr:1 row_mask:0xf bank_mask:0xf bound_ctrl:1
	s_nop 1
	v_add_u32_dpp v169, v169, v169 row_shr:2 row_mask:0xf bank_mask:0xf bound_ctrl:1
	s_nop 1
	v_add_u32_dpp v169, v169, v169 row_shr:4 row_mask:0xf bank_mask:0xf bound_ctrl:1
	s_nop 1
	v_add_u32_dpp v169, v169, v169 row_shr:8 row_mask:0xf bank_mask:0xf bound_ctrl:1
	s_nop 1
	v_add_u32_dpp v169, v169, v169 row_bcast:15 row_mask:0xa bank_mask:0xf
	s_nop 1
	v_add_u32_dpp v169, v169, v169 row_bcast:31 row_mask:0xc bank_mask:0xf
	v_sub_u32 v169, v169, v168
	v_min_u32 v170, 0xffff, v169
	v_min_u32 v171, 0xffff, v168
	v_lshl_or_b32 v170, v171, 16, v170
	ds_write_b32 v249, v170 offset:1344
	v_and_b32 v156, 0xfc, v164
	ds_bpermute_b32 v160, v156, v169
	v_and_b32 v157, 0xfc, v165
	ds_bpermute_b32 v161, v157, v169
	v_and_b32 v158, 0xfc, v166
	ds_bpermute_b32 v162, v158, v169
	v_and_b32 v159, 0xfc, v167
	ds_bpermute_b32 v163, v159, v169
	s_waitcnt lgkmcnt(0)
	v_and_b32 v164, 3, v164
	v_lshlrev_b32 v164, 1, v164
	v_lshl_add_u32 v160, v160, 3, v164
	v_and_b32 v165, 3, v165
	v_lshlrev_b32 v165, 1, v165
	v_lshl_add_u32 v161, v161, 3, v165
	v_and_b32 v166, 3, v166
	v_lshlrev_b32 v166, 1, v166
	v_lshl_add_u32 v162, v162, 3, v166
	v_and_b32 v167, 3, v167
	v_lshlrev_b32 v167, 1, v167
	v_lshl_add_u32 v163, v163, 3, v167
	s_mov_b64 exec, s[84:85]
	ds_write_b128 v248, v[160:163] offset:3072
	s_mov_b64 exec, -1
K2_p6:
	s_waitcnt lgkmcnt(0)
	s_barrier
	v_lshlrev_b32 v249, 2, v246
	ds_read_b32 v250, v249 offset:1344
	s_waitcnt lgkmcnt(0)
	v_and_b32 v251, 0xffff, v250
	v_lshrrev_b32 v232, 16, v250
	v_mov_b32 v226, v251
	v_readlane_b32 s31, v251, 63
	s_nop 0
	s_cmp_gt_u32 s31, 511
	s_cbranch_scc1 K2_slow
	s_mov_b64 exec, s[40:41]
	v_lshrrev_b32 v161, 22, v2
	v_and_b32 v161, 0x3fc, v161
	ds_read_b32 v176, v161 offset:3072
	s_mov_b64 exec, s[42:43]
	v_lshrrev_b32 v162, 22, v6
	v_and_b32 v162, 0x3fc, v162
	ds_read_b32 v177, v162 offset:3072
	s_mov_b64 exec, s[44:45]
	v_lshrrev_b32 v163, 22, v10
	v_and_b32 v163, 0x3fc, v163
	ds_read_b32 v178, v163 offset:3072
	s_mov_b64 exec, s[46:47]
	v_lshrrev_b32 v164, 22, v14
	v_and_b32 v164, 0x3fc, v164
	ds_read_b32 v179, v164 offset:3072
	s_mov_b64 exec, s[48:49]
	v_lshrrev_b32 v165, 22, v18
	v_and_b32 v165, 0x3fc, v165
	ds_read_b32 v180, v165 offset:3072
	s_mov_b64 exec, s[50:51]
	v_lshrrev_b32 v166, 22, v22
	v_and_b32 v166, 0x3fc, v166
	ds_read_b32 v181, v166 offset:3072
	s_mov_b64 exec, s[52:53]
	v_lshrrev_b32 v167, 22, v26
	v_and_b32 v167, 0x3fc, v167
	ds_read_b32 v182, v167 offset:3072
	s_mov_b64 exec, s[40:41]
	v_lshrrev_b32 v248, 1, v3
	v_and_b32 v249, 1, v3
	v_lshlrev_b32 v250, 5, v247
	v_add_u32 v250, 2147623936, v250
	s_waitcnt lgkmcnt(0)
	v_lshl_add_u32 v248, v248, 3, v176
	v_add_u32 v248, v248, v249
	v_lshlrev_b32 v251, 3, v248
	v_lshlrev_b32 v252, 2, v248
	ds_write_b64 v251, v[0:1] offset:4096
	ds_write_b32 v252, v250 offset:36864
	s_mov_b64 exec, s[42:43]
	v_lshrrev_b32 v248, 1, v7
	v_and_b32 v249, 1, v7
	v_and_b32 v250, 0xffffff, v6
	v_lshlrev_b32 v250, 5, v250
	v_lshl_add_u32 v248, v248, 3, v177
	v_add_u32 v248, v248, v249
	v_lshlrev_b32 v251, 3, v248
	v_lshlrev_b32 v252, 2, v248
	ds_write_b64 v251, v[4:5] offset:4096
	ds_write_b32 v252, v250 offset:36864
	s_mov_b64 exec, s[44:45]
	v_lshrrev_b32 v248, 1, v11
	v_and_b32 v249, 1, v11
	v_and_b32 v250, 0xffffff, v10
	v_lshlrev_b32 v250, 5, v250
	v_lshl_add_u32 v248, v248, 3, v178
	v_add_u32 v248, v248, v249
	v_lshlrev_b32 v251, 3, v248
	v_lshlrev_b32 v252, 2, v248
	ds_write_b64 v251, v[8:9] offset:4096
	ds_write_b32 v252, v250 offset:36864
	s_mov_b64 exec, s[46:47]
	v_lshrrev_b32 v248, 1, v15
	v_and_b32 v249, 1, v15
	v_and_b32 v250, 0xffffff, v14
	v_lshlrev_b32 v250, 5, v250
	v_lshl_add_u32 v248, v248, 3, v179
	v_add_u32 v248, v248, v249
	v_lshlrev_b32 v251, 3, v248
	v_lshlrev_b32 v252, 2, v248
	ds_write_b64 v251, v[12:13] offset:4096
	ds_write_b32 v252, v250 offset:36864
	s_mov_b64 exec, s[48:49]
	v_lshrrev_b32 v248, 1, v19
	v_and_b32 v249, 1, v19
	v_and_b32 v250, 0xffffff, v18
	v_lshlrev_b32 v250, 5, v250
	v_lshl_add_u32 v248, v248, 3, v180
	v_add_u32 v248, v248, v249
	v_lshlrev_b32 v251, 3, v248
	v_lshlrev_b32 v252, 2, v248
	ds_write_b64 v251, v[16:17] offset:4096
	ds_write_b32 v252, v250 offset:36864
	s_mov_b64 exec, s[50:51]
	v_lshrrev_b32 v248, 1, v23
	v_and_b32 v249, 1, v23
	v_and_b32 v250, 0xffffff, v22
	v_lshlrev_b32 v250, 5, v250
	v_lshl_add_u32 v248, v248, 3, v181
	v_add_u32 v248, v248, v249
	v_lshlrev_b32 v251, 3, v248
	v_lshlrev_b32 v252, 2, v248
	ds_write_b64 v251, v[20:21] offset:4096
	ds_write_b32 v252, v250 offset:36864
	s_mov_b64 exec, s[52:53]
	v_lshrrev_b32 v248, 1, v27
	v_and_b32 v249, 1, v27
	v_and_b32 v250, 0xffffff, v26
	v_lshlrev_b32 v250, 5, v250
	v_lshl_add_u32 v248, v248, 3, v182
	v_add_u32 v248, v248, v249
	v_lshlrev_b32 v251, 3, v248
	v_lshlrev_b32 v252, 2, v248
	ds_write_b64 v251, v[24:25] offset:4096
	ds_write_b32 v252, v250 offset:36864
	s_mov_b64 exec, -1
	s_mov_b64 exec, s[54:55]
	v_lshrrev_b32 v161, 22, v30
	v_and_b32 v161, 0x3fc, v161
	ds_read_b32 v176, v161 offset:3072
	s_mov_b64 exec, s[56:57]
	v_lshrrev_b32 v162, 22, v34
	v_and_b32 v162, 0x3fc, v162
	ds_read_b32 v177, v162 offset:3072
	s_mov_b64 exec, s[58:59]
	v_lshrrev_b32 v163, 22, v38
	v_and_b32 v163, 0x3fc, v163
	ds_read_b32 v178, v163 offset:3072
	s_mov_b64 exec, s[60:61]
	v_lshrrev_b32 v164, 22, v42
	v_and_b32 v164, 0x3fc, v164
	ds_read_b32 v179, v164 offset:3072
	s_mov_b64 exec, s[62:63]
	v_lshrrev_b32 v165, 22, v46
	v_and_b32 v165, 0x3fc, v165
	ds_read_b32 v180, v165 offset:3072
	s_mov_b64 exec, s[64:65]
	v_lshrrev_b32 v166, 22, v50
	v_and_b32 v166, 0x3fc, v166
	ds_read_b32 v181, v166 offset:3072
	s_mov_b64 exec, s[66:67]
	v_lshrrev_b32 v167, 22, v54
	v_and_b32 v167, 0x3fc, v167
	ds_read_b32 v182, v167 offset:3072
	s_mov_b64 exec, s[54:55]
	v_lshrrev_b32 v248, 1, v31
	v_and_b32 v249, 1, v31
	v_and_b32 v250, 0xffffff, v30
	v_lshlrev_b32 v250, 5, v250
	s_waitcnt lgkmcnt(0)
	v_lshl_add_u32 v248, v248, 3, v176
	v_add_u32 v248, v248, v249
	v_lshlrev_b32 v251, 3, v248
	v_lshlrev_b32 v252, 2, v248
	ds_write_b64 v251, v[28:29] offset:4096
	ds_write_b32 v252, v250 offset:36864
	s_mov_b64 exec, s[56:57]
	v_lshrrev_b32 v248, 1, v35
	v_and_b32 v249, 1, v35
	v_and_b32 v250, 0xffffff, v34
	v_lshlrev_b32 v250, 5, v250
	v_lshl_add_u32 v248, v248, 3, v177
	v_add_u32 v248, v248, v249
	v_lshlrev_b32 v251, 3, v248
	v_lshlrev_b32 v252, 2, v248
	ds_write_b64 v251, v[32:33] offset:4096
	ds_write_b32 v252, v250 offset:36864
	s_mov_b64 exec, s[58:59]
	v_lshrrev_b32 v248, 1, v39
	v_and_b32 v249, 1, v39
	v_and_b32 v250, 0xffffff, v38
	v_lshlrev_b32 v250, 5, v250
	v_lshl_add_u32 v248, v248, 3, v178
	v_add_u32 v248, v248, v249
	v_lshlrev_b32 v251, 3, v248
	v_lshlrev_b32 v252, 2, v248
	ds_write_b64 v251, v[36:37] offset:4096
	ds_write_b32 v252, v250 offset:36864
	s_mov_b64 exec, s[60:61]
	v_lshrrev_b32 v248, 1, v43
	v_and_b32 v249, 1, v43
	v_and_b32 v250, 0xffffff, v42
	v_lshlrev_b32 v250, 5, v250
	v_lshl_add_u32 v248, v248, 3, v179
	v_add_u32 v248, v248, v249
	v_lshlrev_b32 v251, 3, v248
	v_lshlrev_b32 v252, 2, v248
	ds_write_b64 v251, v[40:41] offset:4096
	ds_write_b32 v252, v250 offset:36864
	s_mov_b64 exec, s[62:63]
	v_lshrrev_b32 v248, 1, v47
	v_and_b32 v249, 1, v47
	v_and_b32 v250, 0xffffff, v46
	v_lshlrev_b32 v250, 5, v250
	v_lshl_add_u32 v248, v248, 3, v180
	v_add_u32 v248, v248, v249
	v_lshlrev_b32 v251, 3, v248
	v_lshlrev_b32 v252, 2, v248
	ds_write_b64 v251, v[44:45] offset:4096
	ds_write_b32 v252, v250 offset:36864
	s_mov_b64 exec, s[64:65]
	v_lshrrev_b32 v248, 1, v51
	v_and_b32 v249, 1, v51
	v_and_b32 v250, 0xffffff, v50
	v_lshlrev_b32 v250, 5, v250
	v_lshl_add_u32 v248, v248, 3, v181
	v_add_u32 v248, v248, v249
	v_lshlrev_b32 v251, 3, v248
	v_lshlrev_b32 v252, 2, v248
	ds_write_b64 v251, v[48:49] offset:4096
	ds_write_b32 v252, v250 offset:36864
	s_mov_b64 exec, s[66:67]
	v_lshrrev_b32 v248, 1, v55
	v_and_b32 v249, 1, v55
	v_and_b32 v250, 0xffffff, v54
	v_lshlrev_b32 v250, 5, v250
	v_lshl_add_u32 v248, v248, 3, v182
	v_add_u32 v248, v248, v249
	v_lshlrev_b32 v251, 3, v248
	v_lshlrev_b32 v252, 2, v248
	ds_write_b64 v251, v[52:53] offset:4096
	ds_write_b32 v252, v250 offset:36864
	s_mov_b64 exec, -1
	s_cmp_eq_u64 s[96:97], 0
	s_cbranch_scc1 K2_nb2c
	s_mov_b64 exec, s[68:69]
	v_lshrrev_b32 v161, 22, v58
	v_and_b32 v161, 0x3fc, v161
	ds_read_b32 v176, v161 offset:3072
	s_mov_b64 exec, s[70:71]
	v_lshrrev_b32 v162, 22, v62
	v_and_b32 v162, 0x3fc, v162
	ds_read_b32 v177, v162 offset:3072
	s_mov_b64 exec, s[72:73]
	v_lshrrev_b32 v163, 22, v66
	v_and_b32 v163, 0x3fc, v163
	ds_read_b32 v178, v163 offset:3072
	s_mov_b64 exec, s[74:75]
	v_lshrrev_b32 v164, 22, v70
	v_and_b32 v164, 0x3fc, v164
	ds_read_b32 v179, v164 offset:3072
	s_mov_b64 exec, s[76:77]
	v_lshrrev_b32 v165, 22, v74
	v_and_b32 v165, 0x3fc, v165
	ds_read_b32 v180, v165 offset:3072
	s_mov_b64 exec, s[78:79]
	v_lshrrev_b32 v166, 22, v78
	v_and_b32 v166, 0x3fc, v166
	ds_read_b32 v181, v166 offset:3072
	s_mov_b64 exec, s[80:81]
	v_lshrrev_b32 v167, 22, v82
	v_and_b32 v167, 0x3fc, v167
	ds_read_b32 v182, v167 offset:3072
	s_mov_b64 exec, s[68:69]
	v_lshrrev_b32 v248, 1, v59
	v_and_b32 v249, 1, v59
	v_and_b32 v250, 0xffffff, v58
	v_lshlrev_b32 v250, 5, v250
	s_waitcnt lgkmcnt(0)
	v_lshl_add_u32 v248, v248, 3, v176
	v_add_u32 v248, v248, v249
	v_lshlrev_b32 v251, 3, v248
	v_lshlrev_b32 v252, 2, v248
	ds_write_b64 v251, v[56:57] offset:4096
	ds_write_b32 v252, v250 offset:36864
	s_mov_b64 exec, s[70:71]
	v_lshrrev_b32 v248, 1, v63
	v_and_b32 v249, 1, v63
	v_and_b32 v250, 0xffffff, v62
	v_lshlrev_b32 v250, 5, v250
	v_lshl_add_u32 v248, v248, 3, v177
	v_add_u32 v248, v248, v249
	v_lshlrev_b32 v251, 3, v248
	v_lshlrev_b32 v252, 2, v248
	ds_write_b64 v251, v[60:61] offset:4096
	ds_write_b32 v252, v250 offset:36864
	s_mov_b64 exec, s[72:73]
	v_lshrrev_b32 v248, 1, v67
	v_and_b32 v249, 1, v67
	v_and_b32 v250, 0xffffff, v66
	v_lshlrev_b32 v250, 5, v250
	v_lshl_add_u32 v248, v248, 3, v178
	v_add_u32 v248, v248, v249
	v_lshlrev_b32 v251, 3, v248
	v_lshlrev_b32 v252, 2, v248
	ds_write_b64 v251, v[64:65] offset:4096
	ds_write_b32 v252, v250 offset:36864
	s_mov_b64 exec, s[74:75]
	v_lshrrev_b32 v248, 1, v71
	v_and_b32 v249, 1, v71
	v_and_b32 v250, 0xffffff, v70
	v_lshlrev_b32 v250, 5, v250
	v_lshl_add_u32 v248, v248, 3, v179
	v_add_u32 v248, v248, v249
	v_lshlrev_b32 v251, 3, v248
	v_lshlrev_b32 v252, 2, v248
	ds_write_b64 v251, v[68:69] offset:4096
	ds_write_b32 v252, v250 offset:36864
	s_mov_b64 exec, s[76:77]
	v_lshrrev_b32 v248, 1, v75
	v_and_b32 v249, 1, v75
	v_and_b32 v250, 0xffffff, v74
	v_lshlrev_b32 v250, 5, v250
	v_lshl_add_u32 v248, v248, 3, v180
	v_add_u32 v248, v248, v249
	v_lshlrev_b32 v251, 3, v248
	v_lshlrev_b32 v252, 2, v248
	ds_write_b64 v251, v[72:73] offset:4096
	ds_write_b32 v252, v250 offset:36864
	s_mov_b64 exec, s[78:79]
	v_lshrrev_b32 v248, 1, v79
	v_and_b32 v249, 1, v79
	v_and_b32 v250, 0xffffff, v78
	v_lshlrev_b32 v250, 5, v250
	v_lshl_add_u32 v248, v248, 3, v181
	v_add_u32 v248, v248, v249
	v_lshlrev_b32 v251, 3, v248
	v_lshlrev_b32 v252, 2, v248
	ds_write_b64 v251, v[76:77] offset:4096
	ds_write_b32 v252, v250 offset:36864
	s_mov_b64 exec, s[80:81]
	v_lshrrev_b32 v248, 1, v83
	v_and_b32 v249, 1, v83
	v_and_b32 v250, 0xffffff, v82
	v_lshlrev_b32 v250, 5, v250
	v_lshl_add_u32 v248, v248, 3, v182
	v_add_u32 v248, v248, v249
	v_lshlrev_b32 v251, 3, v248
	v_lshlrev_b32 v252, 2, v248
	ds_write_b64 v251, v[80:81] offset:4096
	ds_write_b32 v252, v250 offset:36864
	s_mov_b64 exec, -1
K2_nb2c:
	v_lshlrev_b32 v248, 4, v246
	v_add_u32 v248, 94208, v248
	ds_read_b128 v[84:87], v248 offset:0
	ds_read_b128 v[88:91], v248 offset:1024
	ds_read_b128 v[92:95], v248 offset:2048
	ds_read_b128 v[96:99], v248 offset:3072
	ds_read_b128 v[100:103], v248 offset:4096
	ds_read_b128 v[104:107], v248 offset:5120
	ds_read_b128 v[108:111], v248 offset:6144
	ds_read_b128 v[112:115], v248 offset:7168
	ds_read_b128 v[116:119], v248 offset:8192
	ds_read_b128 v[120:123], v248 offset:9216
	v_lshlrev_b32 v249, 5, v247
	v_add_u32 v249, 140288, v249
	s_waitcnt vmcnt(0)
	ds_write_b128 v249, v[184:187]
	ds_write_b128 v249, v[188:191] offset:16
	s_waitcnt lgkmcnt(0)
	s_barrier
	v_mov_b32 v249, v226
	s_mov_b32 s23, s20
	v_readlane_b32 s21, v249, s20
	v_readlane_b32 s31, v232, s20
	v_mov_b32 v248, 0xffff0000
	v_mov_b32 v253, 0x7fffffff
	s_mov_b32 s44, 0x55555555
	s_mov_b32 s45, 0xaaaaaaaa
	v_mov_b32 v156, 0
	v_mov_b32 v157, 0
	v_mov_b32 v158, 0
	v_mov_b32 v159, 0
	v_mov_b32 v160, 0
	v_mov_b32 v161, 0
	v_mov_b32 v162, 0
	v_mov_b32 v163, 0
	v_mov_b32 v246, 1296
	v_mov_b32 v247, 1
	s_add_u32 s22, s21, s31
	s_mov_b64 exec, 1
	ds_add_rtn_u32 v250, v246, v247
	s_mov_b64 exec, -1
	s_lshl_b32 s28, s21, 6
	s_lshr_b32 s29, s28, 1
	v_add_u32 v251, s28, v230
	v_add_u32 v252, s29, v231
	s_waitcnt lgkmcnt(0)
	s_cmp_lg_u32 s21, s22
	s_cbranch_scc0 K2_sw1
K2_have1:
	s_add_u32 s21, s21, 1
	s_cmp_eq_u32 s21, s22
	s_cselect_b32 s40, s23, -1
K2_go1:
	ds_read_b128 v[164:167], v251
	ds_read_b32 v233, v252
	v_add_u32 v251, 64, v251
	v_add_u32 v252, 32, v252
	s_waitcnt lgkmcnt(0)
	v_mad_u32_u16 v234, v164, s26, v228
	v_mad_u32_u16 v235, v166, s26, v228
	v_or_b32 v236, v233, v229
	v_cmp_gt_i32 vcc, 0, v233
	v_and_b32 v237, v253, v236
	s_andn2_b64 exec, s[44:45], vcc
	buffer_load_dwordx4 v[156:159], v236, s[8:11], 0 offen sc1 nt
	s_and_b64 exec, s[44:45], vcc
	ds_read_b128 v[156:159], v237
	s_mov_b64 exec, -1
	buffer_load_dwordx2 v[124:125], v234, s[4:7], 0 offen offset:0
	buffer_load_dwordx2 v[126:127], v234, s[4:7], 0 offen offset:128
	buffer_load_dwordx2 v[128:129], v234, s[4:7], 0 offen offset:256
	buffer_load_dwordx2 v[130:131], v234, s[4:7], 0 offen offset:384
	buffer_load_dwordx2 v[132:133], v235, s[4:7], 0 offen offset:0
	buffer_load_dwordx2 v[134:135], v235, s[4:7], 0 offen offset:128
	buffer_load_dwordx2 v[136:137], v235, s[4:7], 0 offen offset:256
	buffer_load_dwordx2 v[138:139], v235, s[4:7], 0 offen offset:384
	s_cmp_lg_u32 s21, s22
	s_cbranch_scc0 K2_sw2
K2_have2:
	s_add_u32 s21, s21, 1
	s_cmp_eq_u32 s21, s22
	s_cselect_b32 s41, s23, -1
K2_go2:
	ds_read_b128 v[168:171], v251
	ds_read_b32 v233, v252
	v_add_u32 v251, 64, v251
	v_add_u32 v252, 32, v252
	s_waitcnt lgkmcnt(0)
	v_mad_u32_u16 v234, v168, s26, v228
	v_mad_u32_u16 v235, v170, s26, v228
	v_or_b32 v236, v233, v229
	v_cmp_gt_i32 vcc, 0, v233
	v_and_b32 v237, v253, v236
	s_andn2_b64 exec, s[44:45], vcc
	buffer_load_dwordx4 v[160:163], v236, s[8:11], 0 offen sc1 nt
	s_and_b64 exec, s[44:45], vcc
	ds_read_b128 v[160:163], v237
	s_mov_b64 exec, -1
	buffer_load_dwordx2 v[140:141], v234, s[4:7], 0 offen offset:0
	buffer_load_dwordx2 v[142:143], v234, s[4:7], 0 offen offset:128
	buffer_load_dwordx2 v[144:145], v234, s[4:7], 0 offen offset:256
	buffer_load_dwordx2 v[146:147], v234, s[4:7], 0 offen offset:384
	buffer_load_dwordx2 v[148:149], v235, s[4:7], 0 offen offset:0
	buffer_load_dwordx2 v[150:151], v235, s[4:7], 0 offen offset:128
	buffer_load_dwordx2 v[152:153], v235, s[4:7], 0 offen offset:256
	buffer_load_dwordx2 v[154:155], v235, s[4:7], 0 offen offset:384
	v_mov_b32 v0, 0
	v_mov_b32 v1, 0
	v_mov_b32 v2, 0
	v_mov_b32 v3, 0
	v_mov_b32 v4, 0
	v_mov_b32 v5, 0
	v_mov_b32 v6, 0
	v_mov_b32 v7, 0
	v_mov_b32 v8, 0
	v_mov_b32 v9, 0
	v_mov_b32 v10, 0
	v_mov_b32 v11, 0
	v_mov_b32 v12, 0
	v_mov_b32 v13, 0
	v_mov_b32 v14, 0
	v_mov_b32 v15, 0
	v_mov_b32 v16, 0
	v_mov_b32 v17, 0
	v_mov_b32 v18, 0
	v_mov_b32 v19, 0
	v_mov_b32 v20, 0
	v_mov_b32 v21, 0
	v_mov_b32 v22, 0
	v_mov_b32 v23, 0
	v_mov_b32 v24, 0
	v_mov_b32 v25, 0
	v_mov_b32 v26, 0
	v_mov_b32 v27, 0
	v_mov_b32 v28, 0
	v_mov_b32 v29, 0
	v_mov_b32 v30, 0
	v_mov_b32 v31, 0
	v_mov_b32 v32, 0
	v_mov_b32 v33, 0
	v_mov_b32 v34, 0
	v_mov_b32 v35, 0
	v_mov_b32 v36, 0
	v_mov_b32 v37, 0
	v_mov_b32 v38, 0
	v_mov_b32 v39, 0
	v_mov_b32 v40, 0
	v_mov_b32 v41, 0
	v_mov_b32 v42, 0
	v_mov_b32 v43, 0
K2_s0:
	s_mov_b32 s25, s40
	v_and_b32 v196, v248, v164
	v_lshlrev_b32 v198, 16, v165
	v_and_b32 v200, v248, v165
	v_and_b32 v202, v248, v166
	v_lshlrev_b32 v204, 16, v167
	v_and_b32 v206, v248, v167
	s_cmp_lg_u32 s21, s22
	s_cbranch_scc0 K2_sw3
K2_have3:
	s_add_u32 s21, s21, 1
	s_cmp_eq_u32 s21, s22
	s_cselect_b32 s40, s23, -1
K2_go3:
	ds_read_b128 v[164:167], v251
	ds_read_b32 v233, v252
	v_add_u32 v251, 64, v251
	v_add_u32 v252, 32, v252
	s_waitcnt vmcnt(9)
	v_mfma_f32_16x16x32_bf16 v[44:47], v[156:159], v[84:87], 0
	v_mfma_f32_16x16x32_bf16 v[48:51], v[156:159], v[88:91], 0
	v_mfma_f32_16x16x32_bf16 v[60:63], v[156:159], v[100:103], 0
	v_mfma_f32_16x16x32_bf16 v[64:67], v[156:159], v[104:107], 0
	v_mfma_f32_16x16x32_bf16 v[68:71], v[156:159], v[108:111], 0
	v_mfma_f32_16x16x32_bf16 v[72:75], v[156:159], v[112:115], 0
	v_mfma_f32_16x16x32_bf16 v[52:55], v[156:159], v[92:95], 0
	v_mfma_f32_16x16x32_bf16 v[56:59], v[156:159], v[96:99], 0
	v_mfma_f32_16x16x32_bf16 v[76:79], v[156:159], v[116:119], 0
	v_mfma_f32_16x16x32_bf16 v[80:83], v[156:159], v[120:123], 0
	v_lshlrev_b32 v172, 16, v124
	v_and_b32 v173, v248, v124
	v_lshlrev_b32 v180, 16, v125
	v_and_b32 v181, v248, v125
	v_lshlrev_b32 v174, 16, v126
	v_and_b32 v175, v248, v126
	v_lshlrev_b32 v182, 16, v127
	v_and_b32 v183, v248, v127
	v_lshlrev_b32 v176, 16, v128
	v_and_b32 v177, v248, v128
	v_lshlrev_b32 v184, 16, v129
	v_and_b32 v185, v248, v129
	v_lshlrev_b32 v178, 16, v130
	v_and_b32 v179, v248, v130
	v_lshlrev_b32 v186, 16, v131
	v_and_b32 v187, v248, v131
	v_pk_fma_f32 v[0:1], v[172:173], v[44:45], v[0:1]
	v_pk_fma_f32 v[2:3], v[180:181], v[48:49], v[2:3]
	v_pk_mul_f32 v[188:189], v[174:175], v[196:197] op_sel:[0,0] op_sel_hi:[1,0]
	v_pk_mul_f32 v[190:191], v[182:183], v[196:197] op_sel:[0,0] op_sel_hi:[1,0]
	v_pk_mul_f32 v[192:193], v[172:173], v[60:61]
	v_pk_mul_f32 v[194:195], v[180:181], v[64:65]
	v_pk_fma_f32 v[188:189], v[176:177], v[198:199], v[188:189] op_sel:[0,0,0] op_sel_hi:[1,0,1]
	v_pk_fma_f32 v[190:191], v[184:185], v[198:199], v[190:191] op_sel:[0,0,0] op_sel_hi:[1,0,1]
	v_pk_fma_f32 v[20:21], v[174:175], v[68:69], v[20:21]
	v_pk_fma_f32 v[22:23], v[182:183], v[72:73], v[22:23]
	v_pk_fma_f32 v[188:189], v[178:179], v[200:201], v[188:189] op_sel:[0,0,0] op_sel_hi:[1,0,1]
	v_pk_fma_f32 v[190:191], v[186:187], v[200:201], v[190:191] op_sel:[0,0,0] op_sel_hi:[1,0,1]
	v_pk_fma_f32 v[8:9], v[192:193], v[196:197], v[8:9] op_sel:[0,0,0] op_sel_hi:[1,0,1]
	v_pk_fma_f32 v[10:11], v[194:195], v[196:197], v[10:11] op_sel:[0,0,0] op_sel_hi:[1,0,1]
	v_pk_fma_f32 v[24:25], v[176:177], v[68:69], v[24:25]
	v_pk_fma_f32 v[26:27], v[184:185], v[72:73], v[26:27]
	v_pk_fma_f32 v[12:13], v[192:193], v[198:199], v[12:13] op_sel:[0,0,0] op_sel_hi:[1,0,1]
	v_pk_fma_f32 v[14:15], v[194:195], v[198:199], v[14:15] op_sel:[0,0,0] op_sel_hi:[1,0,1]
	v_pk_fma_f32 v[28:29], v[178:179], v[68:69], v[28:29]
	v_pk_fma_f32 v[30:31], v[186:187], v[72:73], v[30:31]
	v_pk_fma_f32 v[16:17], v[192:193], v[200:201], v[16:17] op_sel:[0,0,0] op_sel_hi:[1,0,1]
	v_pk_fma_f32 v[18:19], v[194:195], v[200:201], v[18:19] op_sel:[0,0,0] op_sel_hi:[1,0,1]
	v_pk_fma_f32 v[4:5], v[188:189], v[52:53], v[4:5]
	v_pk_fma_f32 v[6:7], v[190:191], v[56:57], v[6:7]
	v_pk_mul_f32 v[174:175], v[174:175], v[76:77]
	v_pk_mul_f32 v[182:183], v[182:183], v[80:81]
	v_pk_mul_f32 v[176:177], v[176:177], v[76:77]
	v_pk_mul_f32 v[184:185], v[184:185], v[80:81]
	v_pk_mul_f32 v[178:179], v[178:179], v[76:77]
	v_pk_mul_f32 v[186:187], v[186:187], v[80:81]
	v_pk_fma_f32 v[36:37], v[174:175], v[200:201], v[36:37] op_sel:[0,0,0] op_sel_hi:[1,0,1]
	v_pk_fma_f32 v[38:39], v[182:183], v[200:201], v[38:39] op_sel:[0,0,0] op_sel_hi:[1,0,1]
	v_pk_fma_f32 v[40:41], v[176:177], v[196:197], v[40:41] op_sel:[0,0,0] op_sel_hi:[1,0,1]
	v_pk_fma_f32 v[42:43], v[184:185], v[196:197], v[42:43] op_sel:[0,0,0] op_sel_hi:[1,0,1]
	v_pk_fma_f32 v[32:33], v[178:179], v[198:199], v[32:33] op_sel:[0,0,0] op_sel_hi:[1,0,1]
	v_pk_fma_f32 v[34:35], v[186:187], v[198:199], v[34:35] op_sel:[0,0,0] op_sel_hi:[1,0,1]
	v_pk_fma_f32 v[40:41], v[174:175], v[198:199], v[40:41] op_sel:[0,0,0] op_sel_hi:[1,0,1] neg_lo:[0,1,0] neg_hi:[0,1,0]
	v_pk_fma_f32 v[42:43], v[182:183], v[198:199], v[42:43] op_sel:[0,0,0] op_sel_hi:[1,0,1] neg_lo:[0,1,0] neg_hi:[0,1,0]
	v_pk_fma_f32 v[32:33], v[176:177], v[200:201], v[32:33] op_sel:[0,0,0] op_sel_hi:[1,0,1] neg_lo:[0,1,0] neg_hi:[0,1,0]
	v_pk_fma_f32 v[34:35], v[184:185], v[200:201], v[34:35] op_sel:[0,0,0] op_sel_hi:[1,0,1] neg_lo:[0,1,0] neg_hi:[0,1,0]
	v_pk_fma_f32 v[36:37], v[178:179], v[196:197], v[36:37] op_sel:[0,0,0] op_sel_hi:[1,0,1] neg_lo:[0,1,0] neg_hi:[0,1,0]
	v_pk_fma_f32 v[38:39], v[186:187], v[196:197], v[38:39] op_sel:[0,0,0] op_sel_hi:[1,0,1] neg_lo:[0,1,0] neg_hi:[0,1,0]
	v_lshlrev_b32 v172, 16, v132
	v_and_b32 v173, v248, v132
	v_lshlrev_b32 v180, 16, v133
	v_and_b32 v181, v248, v133
	v_lshlrev_b32 v174, 16, v134
	v_and_b32 v175, v248, v134
	v_lshlrev_b32 v182, 16, v135
	v_and_b32 v183, v248, v135
	v_lshlrev_b32 v176, 16, v136
	v_and_b32 v177, v248, v136
	v_lshlrev_b32 v184, 16, v137
	v_and_b32 v185, v248, v137
	v_lshlrev_b32 v178, 16, v138
	v_and_b32 v179, v248, v138
	v_lshlrev_b32 v186, 16, v139
	v_and_b32 v187, v248, v139
	v_pk_fma_f32 v[0:1], v[172:173], v[46:47], v[0:1]
	v_pk_fma_f32 v[2:3], v[180:181], v[50:51], v[2:3]
	v_pk_mul_f32 v[188:189], v[174:175], v[202:203] op_sel:[0,0] op_sel_hi:[1,0]
	v_pk_mul_f32 v[190:191], v[182:183], v[202:203] op_sel:[0,0] op_sel_hi:[1,0]
	v_pk_mul_f32 v[192:193], v[172:173], v[62:63]
	v_pk_mul_f32 v[194:195], v[180:181], v[66:67]
	v_pk_fma_f32 v[188:189], v[176:177], v[204:205], v[188:189] op_sel:[0,0,0] op_sel_hi:[1,0,1]
	v_pk_fma_f32 v[190:191], v[184:185], v[204:205], v[190:191] op_sel:[0,0,0] op_sel_hi:[1,0,1]
	v_pk_fma_f32 v[20:21], v[174:175], v[70:71], v[20:21]
	v_pk_fma_f32 v[22:23], v[182:183], v[74:75], v[22:23]
	v_pk_fma_f32 v[188:189], v[178:179], v[206:207], v[188:189] op_sel:[0,0,0] op_sel_hi:[1,0,1]
	v_pk_fma_f32 v[190:191], v[186:187], v[206:207], v[190:191] op_sel:[0,0,0] op_sel_hi:[1,0,1]
	v_pk_fma_f32 v[8:9], v[192:193], v[202:203], v[8:9] op_sel:[0,0,0] op_sel_hi:[1,0,1]
	v_pk_fma_f32 v[10:11], v[194:195], v[202:203], v[10:11] op_sel:[0,0,0] op_sel_hi:[1,0,1]
	v_pk_fma_f32 v[24:25], v[176:177], v[70:71], v[24:25]
	v_pk_fma_f32 v[26:27], v[184:185], v[74:75], v[26:27]
	v_pk_fma_f32 v[12:13], v[192:193], v[204:205], v[12:13] op_sel:[0,0,0] op_sel_hi:[1,0,1]
	v_pk_fma_f32 v[14:15], v[194:195], v[204:205], v[14:15] op_sel:[0,0,0] op_sel_hi:[1,0,1]
	v_pk_fma_f32 v[28:29], v[178:179], v[70:71], v[28:29]
	v_pk_fma_f32 v[30:31], v[186:187], v[74:75], v[30:31]
	v_pk_fma_f32 v[16:17], v[192:193], v[206:207], v[16:17] op_sel:[0,0,0] op_sel_hi:[1,0,1]
	v_pk_fma_f32 v[18:19], v[194:195], v[206:207], v[18:19] op_sel:[0,0,0] op_sel_hi:[1,0,1]
	v_pk_fma_f32 v[4:5], v[188:189], v[54:55], v[4:5]
	v_pk_fma_f32 v[6:7], v[190:191], v[58:59], v[6:7]
	v_pk_mul_f32 v[174:175], v[174:175], v[78:79]
	v_pk_mul_f32 v[182:183], v[182:183], v[82:83]
	v_pk_mul_f32 v[176:177], v[176:177], v[78:79]
	v_pk_mul_f32 v[184:185], v[184:185], v[82:83]
	v_pk_mul_f32 v[178:179], v[178:179], v[78:79]
	v_pk_mul_f32 v[186:187], v[186:187], v[82:83]
	v_pk_fma_f32 v[36:37], v[174:175], v[206:207], v[36:37] op_sel:[0,0,0] op_sel_hi:[1,0,1]
	v_pk_fma_f32 v[38:39], v[182:183], v[206:207], v[38:39] op_sel:[0,0,0] op_sel_hi:[1,0,1]
	v_pk_fma_f32 v[40:41], v[176:177], v[202:203], v[40:41] op_sel:[0,0,0] op_sel_hi:[1,0,1]
	v_pk_fma_f32 v[42:43], v[184:185], v[202:203], v[42:43] op_sel:[0,0,0] op_sel_hi:[1,0,1]
	v_pk_fma_f32 v[32:33], v[178:179], v[204:205], v[32:33] op_sel:[0,0,0] op_sel_hi:[1,0,1]
	v_pk_fma_f32 v[34:35], v[186:187], v[204:205], v[34:35] op_sel:[0,0,0] op_sel_hi:[1,0,1]
	v_pk_fma_f32 v[40:41], v[174:175], v[204:205], v[40:41] op_sel:[0,0,0] op_sel_hi:[1,0,1] neg_lo:[0,1,0] neg_hi:[0,1,0]
	v_pk_fma_f32 v[42:43], v[182:183], v[204:205], v[42:43] op_sel:[0,0,0] op_sel_hi:[1,0,1] neg_lo:[0,1,0] neg_hi:[0,1,0]
	v_pk_fma_f32 v[32:33], v[176:177], v[206:207], v[32:33] op_sel:[0,0,0] op_sel_hi:[1,0,1] neg_lo:[0,1,0] neg_hi:[0,1,0]
	v_pk_fma_f32 v[34:35], v[184:185], v[206:207], v[34:35] op_sel:[0,0,0] op_sel_hi:[1,0,1] neg_lo:[0,1,0] neg_hi:[0,1,0]
	v_pk_fma_f32 v[36:37], v[178:179], v[202:203], v[36:37] op_sel:[0,0,0] op_sel_hi:[1,0,1] neg_lo:[0,1,0] neg_hi:[0,1,0]
	v_pk_fma_f32 v[38:39], v[186:187], v[202:203], v[38:39] op_sel:[0,0,0] op_sel_hi:[1,0,1] neg_lo:[0,1,0] neg_hi:[0,1,0]
	s_setprio 1
	s_waitcnt lgkmcnt(0)
	v_mad_u32_u16 v234, v164, s26, v228
	v_mad_u32_u16 v235, v166, s26, v228
	v_or_b32 v236, v233, v229
	v_cmp_gt_i32 vcc, 0, v233
	v_and_b32 v237, v253, v236
	s_andn2_b64 exec, s[44:45], vcc
	buffer_load_dwordx4 v[156:159], v236, s[8:11], 0 offen sc1 nt
	s_and_b64 exec, s[44:45], vcc
	ds_read_b128 v[156:159], v237
	s_mov_b64 exec, -1
	buffer_load_dwordx2 v[124:125], v234, s[4:7], 0 offen offset:0
	buffer_load_dwordx2 v[126:127], v234, s[4:7], 0 offen offset:128
	buffer_load_dwordx2 v[128:129], v234, s[4:7], 0 offen offset:256
	buffer_load_dwordx2 v[130:131], v234, s[4:7], 0 offen offset:384
	buffer_load_dwordx2 v[132:133], v235, s[4:7], 0 offen offset:0
	buffer_load_dwordx2 v[134:135], v235, s[4:7], 0 offen offset:128
	buffer_load_dwordx2 v[136:137], v235, s[4:7], 0 offen offset:256
	buffer_load_dwordx2 v[138:139], v235, s[4:7], 0 offen offset:384
	s_setprio 0
	s_cmp_lt_i32 s25, 0
	s_cbranch_scc0 K2_fl0
K2_s1:
	s_mov_b32 s25, s41
	v_and_b32 v196, v248, v168
	v_lshlrev_b32 v198, 16, v169
	v_and_b32 v200, v248, v169
	v_and_b32 v202, v248, v170
	v_lshlrev_b32 v204, 16, v171
	v_and_b32 v206, v248, v171
	s_cmp_lg_u32 s21, s22
	s_cbranch_scc0 K2_sw4
K2_have4:
	s_add_u32 s21, s21, 1
	s_cmp_eq_u32 s21, s22
	s_cselect_b32 s41, s23, -1
K2_go4:
	ds_read_b128 v[168:171], v251
	ds_read_b32 v233, v252
	v_add_u32 v251, 64, v251
	v_add_u32 v252, 32, v252
	s_waitcnt vmcnt(9)
	v_mfma_f32_16x16x32_bf16 v[44:47], v[160:163], v[84:87], 0
	v_mfma_f32_16x16x32_bf16 v[48:51], v[160:163], v[88:91], 0
	v_mfma_f32_16x16x32_bf16 v[60:63], v[160:163], v[100:103], 0
	v_mfma_f32_16x16x32_bf16 v[64:67], v[160:163], v[104:107], 0
	v_mfma_f32_16x16x32_bf16 v[68:71], v[160:163], v[108:111], 0
	v_mfma_f32_16x16x32_bf16 v[72:75], v[160:163], v[112:115], 0
	v_mfma_f32_16x16x32_bf16 v[52:55], v[160:163], v[92:95], 0
	v_mfma_f32_16x16x32_bf16 v[56:59], v[160:163], v[96:99], 0
	v_mfma_f32_16x16x32_bf16 v[76:79], v[160:163], v[116:119], 0
	v_mfma_f32_16x16x32_bf16 v[80:83], v[160:163], v[120:123], 0
	v_lshlrev_b32 v172, 16, v140
	v_and_b32 v173, v248, v140
	v_lshlrev_b32 v180, 16, v141
	v_and_b32 v181, v248, v141
	v_lshlrev_b32 v174, 16, v142
	v_and_b32 v175, v248, v142
	v_lshlrev_b32 v182, 16, v143
	v_and_b32 v183, v248, v143
	v_lshlrev_b32 v176, 16, v144
	v_and_b32 v177, v248, v144
	v_lshlrev_b32 v184, 16, v145
	v_and_b32 v185, v248, v145
	v_lshlrev_b32 v178, 16, v146
	v_and_b32 v179, v248, v146
	v_lshlrev_b32 v186, 16, v147
	v_and_b32 v187, v248, v147
	v_pk_fma_f32 v[0:1], v[172:173], v[44:45], v[0:1]
	v_pk_fma_f32 v[2:3], v[180:181], v[48:49], v[2:3]
	v_pk_mul_f32 v[188:189], v[174:175], v[196:197] op_sel:[0,0] op_sel_hi:[1,0]
	v_pk_mul_f32 v[190:191], v[182:183], v[196:197] op_sel:[0,0] op_sel_hi:[1,0]
	v_pk_mul_f32 v[192:193], v[172:173], v[60:61]
	v_pk_mul_f32 v[194:195], v[180:181], v[64:65]
	v_pk_fma_f32 v[188:189], v[176:177], v[198:199], v[188:189] op_sel:[0,0,0] op_sel_hi:[1,0,1]
	v_pk_fma_f32 v[190:191], v[184:185], v[198:199], v[190:191] op_sel:[0,0,0] op_sel_hi:[1,0,1]
	v_pk_fma_f32 v[20:21], v[174:175], v[68:69], v[20:21]
	v_pk_fma_f32 v[22:23], v[182:183], v[72:73], v[22:23]
	v_pk_fma_f32 v[188:189], v[178:179], v[200:201], v[188:189] op_sel:[0,0,0] op_sel_hi:[1,0,1]
	v_pk_fma_f32 v[190:191], v[186:187], v[200:201], v[190:191] op_sel:[0,0,0] op_sel_hi:[1,0,1]
	v_pk_fma_f32 v[8:9], v[192:193], v[196:197], v[8:9] op_sel:[0,0,0] op_sel_hi:[1,0,1]
	v_pk_fma_f32 v[10:11], v[194:195], v[196:197], v[10:11] op_sel:[0,0,0] op_sel_hi:[1,0,1]
	v_pk_fma_f32 v[24:25], v[176:177], v[68:69], v[24:25]
	v_pk_fma_f32 v[26:27], v[184:185], v[72:73], v[26:27]
	v_pk_fma_f32 v[12:13], v[192:193], v[198:199], v[12:13] op_sel:[0,0,0] op_sel_hi:[1,0,1]
	v_pk_fma_f32 v[14:15], v[194:195], v[198:199], v[14:15] op_sel:[0,0,0] op_sel_hi:[1,0,1]
	v_pk_fma_f32 v[28:29], v[178:179], v[68:69], v[28:29]
	v_pk_fma_f32 v[30:31], v[186:187], v[72:73], v[30:31]
	v_pk_fma_f32 v[16:17], v[192:193], v[200:201], v[16:17] op_sel:[0,0,0] op_sel_hi:[1,0,1]
	v_pk_fma_f32 v[18:19], v[194:195], v[200:201], v[18:19] op_sel:[0,0,0] op_sel_hi:[1,0,1]
	v_pk_fma_f32 v[4:5], v[188:189], v[52:53], v[4:5]
	v_pk_fma_f32 v[6:7], v[190:191], v[56:57], v[6:7]
	v_pk_mul_f32 v[174:175], v[174:175], v[76:77]
	v_pk_mul_f32 v[182:183], v[182:183], v[80:81]
	v_pk_mul_f32 v[176:177], v[176:177], v[76:77]
	v_pk_mul_f32 v[184:185], v[184:185], v[80:81]
	v_pk_mul_f32 v[178:179], v[178:179], v[76:77]
	v_pk_mul_f32 v[186:187], v[186:187], v[80:81]
	v_pk_fma_f32 v[36:37], v[174:175], v[200:201], v[36:37] op_sel:[0,0,0] op_sel_hi:[1,0,1]
	v_pk_fma_f32 v[38:39], v[182:183], v[200:201], v[38:39] op_sel:[0,0,0] op_sel_hi:[1,0,1]
	v_pk_fma_f32 v[40:41], v[176:177], v[196:197], v[40:41] op_sel:[0,0,0] op_sel_hi:[1,0,1]
	v_pk_fma_f32 v[42:43], v[184:185], v[196:197], v[42:43] op_sel:[0,0,0] op_sel_hi:[1,0,1]
	v_pk_fma_f32 v[32:33], v[178:179], v[198:199], v[32:33] op_sel:[0,0,0] op_sel_hi:[1,0,1]
	v_pk_fma_f32 v[34:35], v[186:187], v[198:199], v[34:35] op_sel:[0,0,0] op_sel_hi:[1,0,1]
	v_pk_fma_f32 v[40:41], v[174:175], v[198:199], v[40:41] op_sel:[0,0,0] op_sel_hi:[1,0,1] neg_lo:[0,1,0] neg_hi:[0,1,0]
	v_pk_fma_f32 v[42:43], v[182:183], v[198:199], v[42:43] op_sel:[0,0,0] op_sel_hi:[1,0,1] neg_lo:[0,1,0] neg_hi:[0,1,0]
	v_pk_fma_f32 v[32:33], v[176:177], v[200:201], v[32:33] op_sel:[0,0,0] op_sel_hi:[1,0,1] neg_lo:[0,1,0] neg_hi:[0,1,0]
	v_pk_fma_f32 v[34:35], v[184:185], v[200:201], v[34:35] op_sel:[0,0,0] op_sel_hi:[1,0,1] neg_lo:[0,1,0] neg_hi:[0,1,0]
	v_pk_fma_f32 v[36:37], v[178:179], v[196:197], v[36:37] op_sel:[0,0,0] op_sel_hi:[1,0,1] neg_lo:[0,1,0] neg_hi:[0,1,0]
	v_pk_fma_f32 v[38:39], v[186:187], v[196:197], v[38:39] op_sel:[0,0,0] op_sel_hi:[1,0,1] neg_lo:[0,1,0] neg_hi:[0,1,0]
	v_lshlrev_b32 v172, 16, v148
	v_and_b32 v173, v248, v148
	v_lshlrev_b32 v180, 16, v149
	v_and_b32 v181, v248, v149
	v_lshlrev_b32 v174, 16, v150
	v_and_b32 v175, v248, v150
	v_lshlrev_b32 v182, 16, v151
	v_and_b32 v183, v248, v151
	v_lshlrev_b32 v176, 16, v152
	v_and_b32 v177, v248, v152
	v_lshlrev_b32 v184, 16, v153
	v_and_b32 v185, v248, v153
	v_lshlrev_b32 v178, 16, v154
	v_and_b32 v179, v248, v154
	v_lshlrev_b32 v186, 16, v155
	v_and_b32 v187, v248, v155
	v_pk_fma_f32 v[0:1], v[172:173], v[46:47], v[0:1]
	v_pk_fma_f32 v[2:3], v[180:181], v[50:51], v[2:3]
	v_pk_mul_f32 v[188:189], v[174:175], v[202:203] op_sel:[0,0] op_sel_hi:[1,0]
	v_pk_mul_f32 v[190:191], v[182:183], v[202:203] op_sel:[0,0] op_sel_hi:[1,0]
	v_pk_mul_f32 v[192:193], v[172:173], v[62:63]
	v_pk_mul_f32 v[194:195], v[180:181], v[66:67]
	v_pk_fma_f32 v[188:189], v[176:177], v[204:205], v[188:189] op_sel:[0,0,0] op_sel_hi:[1,0,1]
	v_pk_fma_f32 v[190:191], v[184:185], v[204:205], v[190:191] op_sel:[0,0,0] op_sel_hi:[1,0,1]
	v_pk_fma_f32 v[20:21], v[174:175], v[70:71], v[20:21]
	v_pk_fma_f32 v[22:23], v[182:183], v[74:75], v[22:23]
	v_pk_fma_f32 v[188:189], v[178:179], v[206:207], v[188:189] op_sel:[0,0,0] op_sel_hi:[1,0,1]
	v_pk_fma_f32 v[190:191], v[186:187], v[206:207], v[190:191] op_sel:[0,0,0] op_sel_hi:[1,0,1]
	v_pk_fma_f32 v[8:9], v[192:193], v[202:203], v[8:9] op_sel:[0,0,0] op_sel_hi:[1,0,1]
	v_pk_fma_f32 v[10:11], v[194:195], v[202:203], v[10:11] op_sel:[0,0,0] op_sel_hi:[1,0,1]
	v_pk_fma_f32 v[24:25], v[176:177], v[70:71], v[24:25]
	v_pk_fma_f32 v[26:27], v[184:185], v[74:75], v[26:27]
	v_pk_fma_f32 v[12:13], v[192:193], v[204:205], v[12:13] op_sel:[0,0,0] op_sel_hi:[1,0,1]
	v_pk_fma_f32 v[14:15], v[194:195], v[204:205], v[14:15] op_sel:[0,0,0] op_sel_hi:[1,0,1]
	v_pk_fma_f32 v[28:29], v[178:179], v[70:71], v[28:29]
	v_pk_fma_f32 v[30:31], v[186:187], v[74:75], v[30:31]
	v_pk_fma_f32 v[16:17], v[192:193], v[206:207], v[16:17] op_sel:[0,0,0] op_sel_hi:[1,0,1]
	v_pk_fma_f32 v[18:19], v[194:195], v[206:207], v[18:19] op_sel:[0,0,0] op_sel_hi:[1,0,1]
	v_pk_fma_f32 v[4:5], v[188:189], v[54:55], v[4:5]
	v_pk_fma_f32 v[6:7], v[190:191], v[58:59], v[6:7]
	v_pk_mul_f32 v[174:175], v[174:175], v[78:79]
	v_pk_mul_f32 v[182:183], v[182:183], v[82:83]
	v_pk_mul_f32 v[176:177], v[176:177], v[78:79]
	v_pk_mul_f32 v[184:185], v[184:185], v[82:83]
	v_pk_mul_f32 v[178:179], v[178:179], v[78:79]
	v_pk_mul_f32 v[186:187], v[186:187], v[82:83]
	v_pk_fma_f32 v[36:37], v[174:175], v[206:207], v[36:37] op_sel:[0,0,0] op_sel_hi:[1,0,1]
	v_pk_fma_f32 v[38:39], v[182:183], v[206:207], v[38:39] op_sel:[0,0,0] op_sel_hi:[1,0,1]
	v_pk_fma_f32 v[40:41], v[176:177], v[202:203], v[40:41] op_sel:[0,0,0] op_sel_hi:[1,0,1]
	v_pk_fma_f32 v[42:43], v[184:185], v[202:203], v[42:43] op_sel:[0,0,0] op_sel_hi:[1,0,1]
	v_pk_fma_f32 v[32:33], v[178:179], v[204:205], v[32:33] op_sel:[0,0,0] op_sel_hi:[1,0,1]
	v_pk_fma_f32 v[34:35], v[186:187], v[204:205], v[34:35] op_sel:[0,0,0] op_sel_hi:[1,0,1]
	v_pk_fma_f32 v[40:41], v[174:175], v[204:205], v[40:41] op_sel:[0,0,0] op_sel_hi:[1,0,1] neg_lo:[0,1,0] neg_hi:[0,1,0]
	v_pk_fma_f32 v[42:43], v[182:183], v[204:205], v[42:43] op_sel:[0,0,0] op_sel_hi:[1,0,1] neg_lo:[0,1,0] neg_hi:[0,1,0]
	v_pk_fma_f32 v[32:33], v[176:177], v[206:207], v[32:33] op_sel:[0,0,0] op_sel_hi:[1,0,1] neg_lo:[0,1,0] neg_hi:[0,1,0]
	v_pk_fma_f32 v[34:35], v[184:185], v[206:207], v[34:35] op_sel:[0,0,0] op_sel_hi:[1,0,1] neg_lo:[0,1,0] neg_hi:[0,1,0]
	v_pk_fma_f32 v[36:37], v[178:179], v[202:203], v[36:37] op_sel:[0,0,0] op_sel_hi:[1,0,1] neg_lo:[0,1,0] neg_hi:[0,1,0]
	v_pk_fma_f32 v[38:39], v[186:187], v[202:203], v[38:39] op_sel:[0,0,0] op_sel_hi:[1,0,1] neg_lo:[0,1,0] neg_hi:[0,1,0]
	s_setprio 1
	s_waitcnt lgkmcnt(0)
	v_mad_u32_u16 v234, v168, s26, v228
	v_mad_u32_u16 v235, v170, s26, v228
	v_or_b32 v236, v233, v229
	v_cmp_gt_i32 vcc, 0, v233
	v_and_b32 v237, v253, v236
	s_andn2_b64 exec, s[44:45], vcc
	buffer_load_dwordx4 v[160:163], v236, s[8:11], 0 offen sc1 nt
	s_and_b64 exec, s[44:45], vcc
	ds_read_b128 v[160:163], v237
	s_mov_b64 exec, -1
	buffer_load_dwordx2 v[140:141], v234, s[4:7], 0 offen offset:0
	buffer_load_dwordx2 v[142:143], v234, s[4:7], 0 offen offset:128
	buffer_load_dwordx2 v[144:145], v234, s[4:7], 0 offen offset:256
	buffer_load_dwordx2 v[146:147], v234, s[4:7], 0 offen offset:384
	buffer_load_dwordx2 v[148:149], v235, s[4:7], 0 offen offset:0
	buffer_load_dwordx2 v[150:151], v235, s[4:7], 0 offen offset:128
	buffer_load_dwordx2 v[152:153], v235, s[4:7], 0 offen offset:256
	buffer_load_dwordx2 v[154:155], v235, s[4:7], 0 offen offset:384
	s_setprio 0
	s_cmp_lt_i32 s25, 0
	s_cbranch_scc0 K2_fl1
	s_branch K2_s0
K2_fl0:
	s_lshl_b32 s31, s25, 4
	v_add_u32 v237, s31, v245
	ds_read_b32 v238, v237
	v_cvt_pk_bf16_f32 v172, v0, v1
	v_cvt_pk_bf16_f32 v173, v2, v3
	ds_write_b64 v239, v[172:173] offset:0
	v_cvt_pk_bf16_f32 v174, v4, v5
	v_cvt_pk_bf16_f32 v175, v6, v7
	ds_write_b64 v239, v[174:175] offset:128
	v_cvt_pk_bf16_f32 v176, v8, v9
	v_cvt_pk_bf16_f32 v177, v10, v11
	ds_write_b64 v239, v[176:177] offset:256
	v_cvt_pk_bf16_f32 v178, v12, v13
	v_cvt_pk_bf16_f32 v179, v14, v15
	ds_write_b64 v239, v[178:179] offset:640
	v_cvt_pk_bf16_f32 v180, v16, v17
	v_cvt_pk_bf16_f32 v181, v18, v19
	ds_write_b64 v239, v[180:181] offset:1024
	v_cvt_pk_bf16_f32 v182, v20, v21
	v_cvt_pk_bf16_f32 v183, v22, v23
	ds_write_b64 v239, v[182:183] offset:384
	v_cvt_pk_bf16_f32 v184, v24, v25
	v_cvt_pk_bf16_f32 v185, v26, v27
	ds_write_b64 v239, v[184:185] offset:768
	v_cvt_pk_bf16_f32 v186, v28, v29
	v_cvt_pk_bf16_f32 v187, v30, v31
	ds_write_b64 v239, v[186:187] offset:1152
	v_cvt_pk_bf16_f32 v172, v32, v33
	v_cvt_pk_bf16_f32 v173, v34, v35
	ds_write_b64 v239, v[172:173] offset:512
	v_cvt_pk_bf16_f32 v174, v36, v37
	v_cvt_pk_bf16_f32 v175, v38, v39
	ds_write_b64 v239, v[174:175] offset:896
	v_cvt_pk_bf16_f32 v176, v40, v41
	v_cvt_pk_bf16_f32 v177, v42, v43
	ds_write_b64 v239, v[176:177] offset:1280
	ds_read_b128 v[76:79], v240 offset:0
	ds_read_b128 v[172:175], v242 offset:0
	s_waitcnt lgkmcnt(11)
	ds_read_b128 v[176:179], v242 offset:1024
	ds_read_b128 v[180:183], v242 offset:2048
	ds_read_b128 v[184:187], v242 offset:3072
	ds_read_b128 v[80:83], v240 offset:64
	s_waitcnt lgkmcnt(11)
	ds_read_b128 v[188:191], v242 offset:4096
	ds_read_b128 v[192:195], v242 offset:5120
	ds_read_b128 v[196:199], v242 offset:6144
	ds_read_b128 v[200:203], v242 offset:7168
	v_mov_b32 v0, 0
	v_mov_b32 v1, 0
	v_mov_b32 v2, 0
	v_mov_b32 v3, 0
	v_mov_b32 v4, 0
	v_mov_b32 v5, 0
	v_mov_b32 v6, 0
	v_mov_b32 v7, 0
	v_mov_b32 v8, 0
	v_mov_b32 v9, 0
	v_mov_b32 v10, 0
	v_mov_b32 v11, 0
	v_mov_b32 v12, 0
	v_mov_b32 v13, 0
	v_mov_b32 v14, 0
	v_mov_b32 v15, 0
	v_mov_b32 v16, 0
	v_mov_b32 v17, 0
	v_mov_b32 v18, 0
	v_mov_b32 v19, 0
	v_mov_b32 v20, 0
	v_mov_b32 v21, 0
	v_mov_b32 v22, 0
	v_mov_b32 v23, 0
	v_mov_b32 v24, 0
	v_mov_b32 v25, 0
	v_mov_b32 v26, 0
	v_mov_b32 v27, 0
	v_mov_b32 v28, 0
	v_mov_b32 v29, 0
	v_mov_b32 v30, 0
	v_mov_b32 v31, 0
	v_mov_b32 v32, 0
	v_mov_b32 v33, 0
	v_mov_b32 v34, 0
	v_mov_b32 v35, 0
	v_mov_b32 v36, 0
	v_mov_b32 v37, 0
	v_mov_b32 v38, 0
	v_mov_b32 v39, 0
	v_mov_b32 v40, 0
	v_mov_b32 v41, 0
	v_mov_b32 v42, 0
	v_mov_b32 v43, 0
	s_waitcnt lgkmcnt(5)
	v_mfma_f32_16x16x32_bf16 v[44:47], v[172:175], v[76:79], 0
	v_mfma_f32_16x16x32_bf16 v[48:51], v[176:179], v[76:79], 0
	v_mfma_f32_16x16x32_bf16 v[52:55], v[180:183], v[76:79], 0
	v_mfma_f32_16x16x32_bf16 v[56:59], v[184:187], v[76:79], 0
	ds_read_b128 v[76:79], v240 offset:128
	ds_read_b128 v[172:175], v242 offset:8192
	ds_read_b128 v[176:179], v242 offset:9216
	ds_read_b128 v[180:183], v242 offset:10240
	ds_read_b128 v[184:187], v242 offset:11264
	s_waitcnt lgkmcnt(5)
	v_mfma_f32_16x16x32_bf16 v[44:47], v[188:191], v[80:83], v[44:47]
	v_mfma_f32_16x16x32_bf16 v[48:51], v[192:195], v[80:83], v[48:51]
	v_mfma_f32_16x16x32_bf16 v[52:55], v[196:199], v[80:83], v[52:55]
	v_mfma_f32_16x16x32_bf16 v[56:59], v[200:203], v[80:83], v[56:59]
	ds_read_b128 v[80:83], v240 offset:192
	ds_read_b128 v[188:191], v242 offset:12288
	ds_read_b128 v[192:195], v242 offset:13312
	ds_read_b128 v[196:199], v242 offset:14336
	ds_read_b128 v[200:203], v242 offset:15360
	s_waitcnt lgkmcnt(5)
	v_mfma_f32_16x16x32_bf16 v[44:47], v[172:175], v[76:79], v[44:47]
	v_mfma_f32_16x16x32_bf16 v[48:51], v[176:179], v[76:79], v[48:51]
	v_mfma_f32_16x16x32_bf16 v[52:55], v[180:183], v[76:79], v[52:55]
	v_mfma_f32_16x16x32_bf16 v[56:59], v[184:187], v[76:79], v[56:59]
	ds_read_b128 v[76:79], v241 offset:0
	ds_read_b128 v[172:175], v242 offset:16384
	ds_read_b128 v[176:179], v242 offset:17408
	ds_read_b128 v[180:183], v242 offset:18432
	ds_read_b128 v[184:187], v242 offset:19456
	s_waitcnt lgkmcnt(5)
	v_mfma_f32_16x16x32_bf16 v[44:47], v[188:191], v[80:83], v[44:47]
	v_mfma_f32_16x16x32_bf16 v[48:51], v[192:195], v[80:83], v[48:51]
	v_mfma_f32_16x16x32_bf16 v[52:55], v[196:199], v[80:83], v[52:55]
	v_mfma_f32_16x16x32_bf16 v[56:59], v[200:203], v[80:83], v[56:59]
	ds_read_b128 v[80:83], v241 offset:64
	ds_read_b128 v[188:191], v242 offset:20480
	ds_read_b128 v[192:195], v242 offset:21504
	ds_read_b128 v[196:199], v242 offset:22528
	ds_read_b128 v[200:203], v242 offset:23552
	s_waitcnt lgkmcnt(5)
	v_mfma_f32_16x16x32_bf16 v[60:63], v[172:175], v[76:79], 0
	v_mfma_f32_16x16x32_bf16 v[64:67], v[176:179], v[76:79], 0
	v_mfma_f32_16x16x32_bf16 v[68:71], v[180:183], v[76:79], 0
	v_mfma_f32_16x16x32_bf16 v[72:75], v[184:187], v[76:79], 0
	ds_read_b128 v[76:79], v241 offset:128
	ds_read_b128 v[172:175], v242 offset:24576
	ds_read_b128 v[176:179], v242 offset:25600
	ds_read_b128 v[180:183], v242 offset:26624
	ds_read_b128 v[184:187], v242 offset:27648
	s_waitcnt lgkmcnt(5)
	v_mfma_f32_16x16x32_bf16 v[60:63], v[188:191], v[80:83], v[60:63]
	v_mfma_f32_16x16x32_bf16 v[64:67], v[192:195], v[80:83], v[64:67]
	v_mfma_f32_16x16x32_bf16 v[68:71], v[196:199], v[80:83], v[68:71]
	v_mfma_f32_16x16x32_bf16 v[72:75], v[200:203], v[80:83], v[72:75]
	ds_read_b128 v[80:83], v241 offset:192
	ds_read_b128 v[188:191], v242 offset:28672
	ds_read_b128 v[192:195], v242 offset:29696
	ds_read_b128 v[196:199], v242 offset:30720
	ds_read_b128 v[200:203], v242 offset:31744
	s_waitcnt lgkmcnt(5)
	v_mfma_f32_16x16x32_bf16 v[60:63], v[172:175], v[76:79], v[60:63]
	v_mfma_f32_16x16x32_bf16 v[64:67], v[176:179], v[76:79], v[64:67]
	v_mfma_f32_16x16x32_bf16 v[68:71], v[180:183], v[76:79], v[68:71]
	v_mfma_f32_16x16x32_bf16 v[72:75], v[184:187], v[76:79], v[72:75]
	ds_read_b128 v[76:79], v241 offset:256
	ds_read_b128 v[172:175], v242 offset:32768
	ds_read_b128 v[176:179], v242 offset:33792
	ds_read_b128 v[180:183], v242 offset:34816
	ds_read_b128 v[184:187], v242 offset:35840
	s_waitcnt lgkmcnt(5)
	v_mfma_f32_16x16x32_bf16 v[60:63], v[188:191], v[80:83], v[60:63]
	v_mfma_f32_16x16x32_bf16 v[64:67], v[192:195], v[80:83], v[64:67]
	v_mfma_f32_16x16x32_bf16 v[68:71], v[196:199], v[80:83], v[68:71]
	v_mfma_f32_16x16x32_bf16 v[72:75], v[200:203], v[80:83], v[72:75]
	ds_read_b128 v[80:83], v241 offset:320
	ds_read_b128 v[188:191], v242 offset:36864
	ds_read_b128 v[192:195], v242 offset:37888
	ds_read_b128 v[196:199], v242 offset:38912
	ds_read_b128 v[200:203], v242 offset:39936
	s_waitcnt lgkmcnt(5)
	v_mfma_f32_16x16x32_bf16 v[60:63], v[172:175], v[76:79], v[60:63]
	v_mfma_f32_16x16x32_bf16 v[64:67], v[176:179], v[76:79], v[64:67]
	v_mfma_f32_16x16x32_bf16 v[68:71], v[180:183], v[76:79], v[68:71]
	v_mfma_f32_16x16x32_bf16 v[72:75], v[184:187], v[76:79], v[72:75]
	s_waitcnt lgkmcnt(0)
	v_mfma_f32_16x16x32_bf16 v[60:63], v[188:191], v[80:83], v[60:63]
	v_mfma_f32_16x16x32_bf16 v[64:67], v[192:195], v[80:83], v[64:67]
	v_mfma_f32_16x16x32_bf16 v[68:71], v[196:199], v[80:83], v[68:71]
	v_mfma_f32_16x16x32_bf16 v[72:75], v[200:203], v[80:83], v[72:75]
	v_and_b32 v238, 0xff, v238
	v_lshl_add_u32 v238, v238, 9, s30
	v_add_u32 v237, v238, v243
	v_add_u32 v238, v238, v244
	s_mov_b64 exec, s[32:33]
	v_mov_b32 v44, v48
	v_mov_b32 v45, v49
	v_mov_b32 v46, v50
	v_mov_b32 v47, v51
	s_mov_b64 exec, s[34:35]
	v_mov_b32 v44, v52
	v_mov_b32 v45, v53
	v_mov_b32 v46, v54
	v_mov_b32 v47, v55
	s_mov_b64 exec, s[36:37]
	v_mov_b32 v44, v56
	v_mov_b32 v45, v57
	v_mov_b32 v46, v58
	v_mov_b32 v47, v59
	s_mov_b64 exec, -1
	v_mul_f32 v176, 0xbfb8aa3b, v44
	v_mul_f32 v177, 0xbfb8aa3b, v45
	v_mul_f32 v178, 0xbfb8aa3b, v46
	v_mul_f32 v179, 0xbfb8aa3b, v47
	v_exp_f32 v176, v176
	v_exp_f32 v177, v177
	v_exp_f32 v178, v178
	v_exp_f32 v179, v179
	v_add_f32 v176, 1.0, v176
	v_add_f32 v177, 1.0, v177
	v_add_f32 v178, 1.0, v178
	v_add_f32 v179, 1.0, v179
	v_rcp_f32 v176, v176
	v_rcp_f32 v177, v177
	v_rcp_f32 v178, v178
	v_rcp_f32 v179, v179
	v_cvt_pk_bf16_f32 v188, v44, v45
	v_cvt_pk_bf16_f32 v189, v46, v47
	buffer_store_dwordx2 v[188:189], v237, s[12:15], 0 offen nt
	v_mul_f32_dpp v60, v176, v60 quad_perm:[0,0,0,0] row_mask:0xf bank_mask:0xf
	v_mul_f32_dpp v61, v177, v61 quad_perm:[0,0,0,0] row_mask:0xf bank_mask:0xf
	v_mul_f32_dpp v62, v178, v62 quad_perm:[0,0,0,0] row_mask:0xf bank_mask:0xf
	v_mul_f32_dpp v63, v179, v63 quad_perm:[0,0,0,0] row_mask:0xf bank_mask:0xf
	v_mul_f32_dpp v64, v176, v64 quad_perm:[1,1,1,1] row_mask:0xf bank_mask:0xf
	v_mul_f32_dpp v65, v177, v65 quad_perm:[1,1,1,1] row_mask:0xf bank_mask:0xf
	v_mul_f32_dpp v66, v178, v66 quad_perm:[1,1,1,1] row_mask:0xf bank_mask:0xf
	v_mul_f32_dpp v67, v179, v67 quad_perm:[1,1,1,1] row_mask:0xf bank_mask:0xf
	v_mul_f32_dpp v68, v176, v68 quad_perm:[2,2,2,2] row_mask:0xf bank_mask:0xf
	v_mul_f32_dpp v69, v177, v69 quad_perm:[2,2,2,2] row_mask:0xf bank_mask:0xf
	v_mul_f32_dpp v70, v178, v70 quad_perm:[2,2,2,2] row_mask:0xf bank_mask:0xf
	v_mul_f32_dpp v71, v179, v71 quad_perm:[2,2,2,2] row_mask:0xf bank_mask:0xf
	v_mul_f32_dpp v72, v176, v72 quad_perm:[3,3,3,3] row_mask:0xf bank_mask:0xf
	v_mul_f32_dpp v73, v177, v73 quad_perm:[3,3,3,3] row_mask:0xf bank_mask:0xf
	v_mul_f32_dpp v74, v178, v74 quad_perm:[3,3,3,3] row_mask:0xf bank_mask:0xf
	v_mul_f32_dpp v75, v179, v75 quad_perm:[3,3,3,3] row_mask:0xf bank_mask:0xf
	v_cvt_pk_bf16_f32 v180, v60, v61
	v_cvt_pk_bf16_f32 v181, v62, v63
	v_cvt_pk_bf16_f32 v182, v64, v65
	v_cvt_pk_bf16_f32 v183, v66, v67
	v_cvt_pk_bf16_f32 v184, v68, v69
	v_cvt_pk_bf16_f32 v185, v70, v71
	v_cvt_pk_bf16_f32 v186, v72, v73
	v_cvt_pk_bf16_f32 v187, v74, v75
	buffer_store_dwordx4 v[180:183], v238, s[12:15], 0 offen nt
	buffer_store_dwordx4 v[184:187], v238, s[12:15], 0 offen offset:16 nt
	s_cmp_eq_u32 s41, -2
	s_cbranch_scc1 K2_end
	s_branch K2_s1
K2_fl1:
	s_lshl_b32 s31, s25, 4
	v_add_u32 v237, s31, v245
	ds_read_b32 v238, v237
	v_cvt_pk_bf16_f32 v172, v0, v1
	v_cvt_pk_bf16_f32 v173, v2, v3
	ds_write_b64 v239, v[172:173] offset:0
	v_cvt_pk_bf16_f32 v174, v4, v5
	v_cvt_pk_bf16_f32 v175, v6, v7
	ds_write_b64 v239, v[174:175] offset:128
	v_cvt_pk_bf16_f32 v176, v8, v9
	v_cvt_pk_bf16_f32 v177, v10, v11
	ds_write_b64 v239, v[176:177] offset:256
	v_cvt_pk_bf16_f32 v178, v12, v13
	v_cvt_pk_bf16_f32 v179, v14, v15
	ds_write_b64 v239, v[178:179] offset:640
	v_cvt_pk_bf16_f32 v180, v16, v17
	v_cvt_pk_bf16_f32 v181, v18, v19
	ds_write_b64 v239, v[180:181] offset:1024
	v_cvt_pk_bf16_f32 v182, v20, v21
	v_cvt_pk_bf16_f32 v183, v22, v23
	ds_write_b64 v239, v[182:183] offset:384
	v_cvt_pk_bf16_f32 v184, v24, v25
	v_cvt_pk_bf16_f32 v185, v26, v27
	ds_write_b64 v239, v[184:185] offset:768
	v_cvt_pk_bf16_f32 v186, v28, v29
	v_cvt_pk_bf16_f32 v187, v30, v31
	ds_write_b64 v239, v[186:187] offset:1152
	v_cvt_pk_bf16_f32 v172, v32, v33
	v_cvt_pk_bf16_f32 v173, v34, v35
	ds_write_b64 v239, v[172:173] offset:512
	v_cvt_pk_bf16_f32 v174, v36, v37
	v_cvt_pk_bf16_f32 v175, v38, v39
	ds_write_b64 v239, v[174:175] offset:896
	v_cvt_pk_bf16_f32 v176, v40, v41
	v_cvt_pk_bf16_f32 v177, v42, v43
	ds_write_b64 v239, v[176:177] offset:1280
	ds_read_b128 v[76:79], v240 offset:0
	ds_read_b128 v[172:175], v242 offset:0
	s_waitcnt lgkmcnt(11)
	ds_read_b128 v[176:179], v242 offset:1024
	ds_read_b128 v[180:183], v242 offset:2048
	ds_read_b128 v[184:187], v242 offset:3072
	ds_read_b128 v[80:83], v240 offset:64
	s_waitcnt lgkmcnt(11)
	ds_read_b128 v[188:191], v242 offset:4096
	ds_read_b128 v[192:195], v242 offset:5120
	ds_read_b128 v[196:199], v242 offset:6144
	ds_read_b128 v[200:203], v242 offset:7168
	v_mov_b32 v0, 0
	v_mov_b32 v1, 0
	v_mov_b32 v2, 0
	v_mov_b32 v3, 0
	v_mov_b32 v4, 0
	v_mov_b32 v5, 0
	v_mov_b32 v6, 0
	v_mov_b32 v7, 0
	v_mov_b32 v8, 0
	v_mov_b32 v9, 0
	v_mov_b32 v10, 0
	v_mov_b32 v11, 0
	v_mov_b32 v12, 0
	v_mov_b32 v13, 0
	v_mov_b32 v14, 0
	v_mov_b32 v15, 0
	v_mov_b32 v16, 0
	v_mov_b32 v17, 0
	v_mov_b32 v18, 0
	v_mov_b32 v19, 0
	v_mov_b32 v20, 0
	v_mov_b32 v21, 0
	v_mov_b32 v22, 0
	v_mov_b32 v23, 0
	v_mov_b32 v24, 0
	v_mov_b32 v25, 0
	v_mov_b32 v26, 0
	v_mov_b32 v27, 0
	v_mov_b32 v28, 0
	v_mov_b32 v29, 0
	v_mov_b32 v30, 0
	v_mov_b32 v31, 0
	v_mov_b32 v32, 0
	v_mov_b32 v33, 0
	v_mov_b32 v34, 0
	v_mov_b32 v35, 0
	v_mov_b32 v36, 0
	v_mov_b32 v37, 0
	v_mov_b32 v38, 0
	v_mov_b32 v39, 0
	v_mov_b32 v40, 0
	v_mov_b32 v41, 0
	v_mov_b32 v42, 0
	v_mov_b32 v43, 0
	s_waitcnt lgkmcnt(5)
	v_mfma_f32_16x16x32_bf16 v[44:47], v[172:175], v[76:79], 0
	v_mfma_f32_16x16x32_bf16 v[48:51], v[176:179], v[76:79], 0
	v_mfma_f32_16x16x32_bf16 v[52:55], v[180:183], v[76:79], 0
	v_mfma_f32_16x16x32_bf16 v[56:59], v[184:187], v[76:79], 0
	ds_read_b128 v[76:79], v240 offset:128
	ds_read_b128 v[172:175], v242 offset:8192
	ds_read_b128 v[176:179], v242 offset:9216
	ds_read_b128 v[180:183], v242 offset:10240
	ds_read_b128 v[184:187], v242 offset:11264
	s_waitcnt lgkmcnt(5)
	v_mfma_f32_16x16x32_bf16 v[44:47], v[188:191], v[80:83], v[44:47]
	v_mfma_f32_16x16x32_bf16 v[48:51], v[192:195], v[80:83], v[48:51]
	v_mfma_f32_16x16x32_bf16 v[52:55], v[196:199], v[80:83], v[52:55]
	v_mfma_f32_16x16x32_bf16 v[56:59], v[200:203], v[80:83], v[56:59]
	ds_read_b128 v[80:83], v240 offset:192
	ds_read_b128 v[188:191], v242 offset:12288
	ds_read_b128 v[192:195], v242 offset:13312
	ds_read_b128 v[196:199], v242 offset:14336
	ds_read_b128 v[200:203], v242 offset:15360
	s_waitcnt lgkmcnt(5)
	v_mfma_f32_16x16x32_bf16 v[44:47], v[172:175], v[76:79], v[44:47]
	v_mfma_f32_16x16x32_bf16 v[48:51], v[176:179], v[76:79], v[48:51]
	v_mfma_f32_16x16x32_bf16 v[52:55], v[180:183], v[76:79], v[52:55]
	v_mfma_f32_16x16x32_bf16 v[56:59], v[184:187], v[76:79], v[56:59]
	ds_read_b128 v[76:79], v241 offset:0
	ds_read_b128 v[172:175], v242 offset:16384
	ds_read_b128 v[176:179], v242 offset:17408
	ds_read_b128 v[180:183], v242 offset:18432
	ds_read_b128 v[184:187], v242 offset:19456
	s_waitcnt lgkmcnt(5)
	v_mfma_f32_16x16x32_bf16 v[44:47], v[188:191], v[80:83], v[44:47]
	v_mfma_f32_16x16x32_bf16 v[48:51], v[192:195], v[80:83], v[48:51]
	v_mfma_f32_16x16x32_bf16 v[52:55], v[196:199], v[80:83], v[52:55]
	v_mfma_f32_16x16x32_bf16 v[56:59], v[200:203], v[80:83], v[56:59]
	ds_read_b128 v[80:83], v241 offset:64
	ds_read_b128 v[188:191], v242 offset:20480
	ds_read_b128 v[192:195], v242 offset:21504
	ds_read_b128 v[196:199], v242 offset:22528
	ds_read_b128 v[200:203], v242 offset:23552
	s_waitcnt lgkmcnt(5)
	v_mfma_f32_16x16x32_bf16 v[60:63], v[172:175], v[76:79], 0
	v_mfma_f32_16x16x32_bf16 v[64:67], v[176:179], v[76:79], 0
	v_mfma_f32_16x16x32_bf16 v[68:71], v[180:183], v[76:79], 0
	v_mfma_f32_16x16x32_bf16 v[72:75], v[184:187], v[76:79], 0
	ds_read_b128 v[76:79], v241 offset:128
	ds_read_b128 v[172:175], v242 offset:24576
	ds_read_b128 v[176:179], v242 offset:25600
	ds_read_b128 v[180:183], v242 offset:26624
	ds_read_b128 v[184:187], v242 offset:27648
	s_waitcnt lgkmcnt(5)
	v_mfma_f32_16x16x32_bf16 v[60:63], v[188:191], v[80:83], v[60:63]
	v_mfma_f32_16x16x32_bf16 v[64:67], v[192:195], v[80:83], v[64:67]
	v_mfma_f32_16x16x32_bf16 v[68:71], v[196:199], v[80:83], v[68:71]
	v_mfma_f32_16x16x32_bf16 v[72:75], v[200:203], v[80:83], v[72:75]
	ds_read_b128 v[80:83], v241 offset:192
	ds_read_b128 v[188:191], v242 offset:28672
	ds_read_b128 v[192:195], v242 offset:29696
	ds_read_b128 v[196:199], v242 offset:30720
	ds_read_b128 v[200:203], v242 offset:31744
	s_waitcnt lgkmcnt(5)
	v_mfma_f32_16x16x32_bf16 v[60:63], v[172:175], v[76:79], v[60:63]
	v_mfma_f32_16x16x32_bf16 v[64:67], v[176:179], v[76:79], v[64:67]
	v_mfma_f32_16x16x32_bf16 v[68:71], v[180:183], v[76:79], v[68:71]
	v_mfma_f32_16x16x32_bf16 v[72:75], v[184:187], v[76:79], v[72:75]
	ds_read_b128 v[76:79], v241 offset:256
	ds_read_b128 v[172:175], v242 offset:32768
	ds_read_b128 v[176:179], v242 offset:33792
	ds_read_b128 v[180:183], v242 offset:34816
	ds_read_b128 v[184:187], v242 offset:35840
	s_waitcnt lgkmcnt(5)
	v_mfma_f32_16x16x32_bf16 v[60:63], v[188:191], v[80:83], v[60:63]
	v_mfma_f32_16x16x32_bf16 v[64:67], v[192:195], v[80:83], v[64:67]
	v_mfma_f32_16x16x32_bf16 v[68:71], v[196:199], v[80:83], v[68:71]
	v_mfma_f32_16x16x32_bf16 v[72:75], v[200:203], v[80:83], v[72:75]
	ds_read_b128 v[80:83], v241 offset:320
	ds_read_b128 v[188:191], v242 offset:36864
	ds_read_b128 v[192:195], v242 offset:37888
	ds_read_b128 v[196:199], v242 offset:38912
	ds_read_b128 v[200:203], v242 offset:39936
	s_waitcnt lgkmcnt(5)
	v_mfma_f32_16x16x32_bf16 v[60:63], v[172:175], v[76:79], v[60:63]
	v_mfma_f32_16x16x32_bf16 v[64:67], v[176:179], v[76:79], v[64:67]
	v_mfma_f32_16x16x32_bf16 v[68:71], v[180:183], v[76:79], v[68:71]
	v_mfma_f32_16x16x32_bf16 v[72:75], v[184:187], v[76:79], v[72:75]
	s_waitcnt lgkmcnt(0)
	v_mfma_f32_16x16x32_bf16 v[60:63], v[188:191], v[80:83], v[60:63]
	v_mfma_f32_16x16x32_bf16 v[64:67], v[192:195], v[80:83], v[64:67]
	v_mfma_f32_16x16x32_bf16 v[68:71], v[196:199], v[80:83], v[68:71]
	v_mfma_f32_16x16x32_bf16 v[72:75], v[200:203], v[80:83], v[72:75]
	v_and_b32 v238, 0xff, v238
	v_lshl_add_u32 v238, v238, 9, s30
	v_add_u32 v237, v238, v243
	v_add_u32 v238, v238, v244
	s_mov_b64 exec, s[32:33]
	v_mov_b32 v44, v48
	v_mov_b32 v45, v49
	v_mov_b32 v46, v50
	v_mov_b32 v47, v51
	s_mov_b64 exec, s[34:35]
	v_mov_b32 v44, v52
	v_mov_b32 v45, v53
	v_mov_b32 v46, v54
	v_mov_b32 v47, v55
	s_mov_b64 exec, s[36:37]
	v_mov_b32 v44, v56
	v_mov_b32 v45, v57
	v_mov_b32 v46, v58
	v_mov_b32 v47, v59
	s_mov_b64 exec, -1
	v_mul_f32 v176, 0xbfb8aa3b, v44
	v_mul_f32 v177, 0xbfb8aa3b, v45
	v_mul_f32 v178, 0xbfb8aa3b, v46
	v_mul_f32 v179, 0xbfb8aa3b, v47
	v_exp_f32 v176, v176
	v_exp_f32 v177, v177
	v_exp_f32 v178, v178
	v_exp_f32 v179, v179
	v_add_f32 v176, 1.0, v176
	v_add_f32 v177, 1.0, v177
	v_add_f32 v178, 1.0, v178
	v_add_f32 v179, 1.0, v179
	v_rcp_f32 v176, v176
	v_rcp_f32 v177, v177
	v_rcp_f32 v178, v178
	v_rcp_f32 v179, v179
	v_cvt_pk_bf16_f32 v188, v44, v45
	v_cvt_pk_bf16_f32 v189, v46, v47
	buffer_store_dwordx2 v[188:189], v237, s[12:15], 0 offen nt
	v_mul_f32_dpp v60, v176, v60 quad_perm:[0,0,0,0] row_mask:0xf bank_mask:0xf
	v_mul_f32_dpp v61, v177, v61 quad_perm:[0,0,0,0] row_mask:0xf bank_mask:0xf
	v_mul_f32_dpp v62, v178, v62 quad_perm:[0,0,0,0] row_mask:0xf bank_mask:0xf
	v_mul_f32_dpp v63, v179, v63 quad_perm:[0,0,0,0] row_mask:0xf bank_mask:0xf
	v_mul_f32_dpp v64, v176, v64 quad_perm:[1,1,1,1] row_mask:0xf bank_mask:0xf
	v_mul_f32_dpp v65, v177, v65 quad_perm:[1,1,1,1] row_mask:0xf bank_mask:0xf
	v_mul_f32_dpp v66, v178, v66 quad_perm:[1,1,1,1] row_mask:0xf bank_mask:0xf
	v_mul_f32_dpp v67, v179, v67 quad_perm:[1,1,1,1] row_mask:0xf bank_mask:0xf
	v_mul_f32_dpp v68, v176, v68 quad_perm:[2,2,2,2] row_mask:0xf bank_mask:0xf
	v_mul_f32_dpp v69, v177, v69 quad_perm:[2,2,2,2] row_mask:0xf bank_mask:0xf
	v_mul_f32_dpp v70, v178, v70 quad_perm:[2,2,2,2] row_mask:0xf bank_mask:0xf
	v_mul_f32_dpp v71, v179, v71 quad_perm:[2,2,2,2] row_mask:0xf bank_mask:0xf
	v_mul_f32_dpp v72, v176, v72 quad_perm:[3,3,3,3] row_mask:0xf bank_mask:0xf
	v_mul_f32_dpp v73, v177, v73 quad_perm:[3,3,3,3] row_mask:0xf bank_mask:0xf
	v_mul_f32_dpp v74, v178, v74 quad_perm:[3,3,3,3] row_mask:0xf bank_mask:0xf
	v_mul_f32_dpp v75, v179, v75 quad_perm:[3,3,3,3] row_mask:0xf bank_mask:0xf
	v_cvt_pk_bf16_f32 v180, v60, v61
	v_cvt_pk_bf16_f32 v181, v62, v63
	v_cvt_pk_bf16_f32 v182, v64, v65
	v_cvt_pk_bf16_f32 v183, v66, v67
	v_cvt_pk_bf16_f32 v184, v68, v69
	v_cvt_pk_bf16_f32 v185, v70, v71
	v_cvt_pk_bf16_f32 v186, v72, v73
	v_cvt_pk_bf16_f32 v187, v74, v75
	buffer_store_dwordx4 v[180:183], v238, s[12:15], 0 offen nt
	buffer_store_dwordx4 v[184:187], v238, s[12:15], 0 offen offset:16 nt
	s_cmp_eq_u32 s40, -2
	s_cbranch_scc1 K2_end
	s_branch K2_s0
K2_sw1:
	v_readfirstlane_b32 s24, v250
	s_nop 0
	s_add_u32 s24, s24, 8
	s_cmp_ge_u32 s24, 49
	s_cbranch_scc1 K2_exh1
	s_mov_b32 s23, s24
	v_readlane_b32 s21, v249, s24
	v_readlane_b32 s31, v232, s24
	s_mov_b64 exec, 1
	ds_add_rtn_u32 v250, v246, v247
	s_mov_b64 exec, -1
	s_add_u32 s22, s21, s31
	s_lshl_b32 s28, s21, 6
	s_lshr_b32 s29, s28, 1
	v_add_u32 v251, s28, v230
	v_add_u32 v252, s29, v231
	s_nop 0
	s_branch K2_have1
K2_exh1:
	v_add_u32 v251, 32704, v230
	v_add_u32 v252, 16352, v231
	s_mov_b32 s40, -2
	s_branch K2_go1
K2_sw2:
	v_readfirstlane_b32 s24, v250
	s_nop 0
	s_add_u32 s24, s24, 8
	s_cmp_ge_u32 s24, 49
	s_cbranch_scc1 K2_exh2
	s_mov_b32 s23, s24
	v_readlane_b32 s21, v249, s24
	v_readlane_b32 s31, v232, s24
	s_mov_b64 exec, 1
	ds_add_rtn_u32 v250, v246, v247
	s_mov_b64 exec, -1
	s_add_u32 s22, s21, s31
	s_lshl_b32 s28, s21, 6
	s_lshr_b32 s29, s28, 1
	v_add_u32 v251, s28, v230
	v_add_u32 v252, s29, v231
	s_nop 0
	s_branch K2_have2
K2_exh2:
	v_add_u32 v251, 32704, v230
	v_add_u32 v252, 16352, v231
	s_mov_b32 s41, -2
	s_branch K2_go2
K2_sw3:
	v_readfirstlane_b32 s24, v250
	s_nop 0
	s_add_u32 s24, s24, 8
	s_cmp_ge_u32 s24, 49
	s_cbranch_scc1 K2_exh3
	s_mov_b32 s23, s24
	v_readlane_b32 s21, v249, s24
	v_readlane_b32 s31, v232, s24
	s_mov_b64 exec, 1
	ds_add_rtn_u32 v250, v246, v247
	s_mov_b64 exec, -1
	s_add_u32 s22, s21, s31
	s_lshl_b32 s28, s21, 6
	s_lshr_b32 s29, s28, 1
	v_add_u32 v251, s28, v230
	v_add_u32 v252, s29, v231
	s_nop 0
	s_branch K2_have3
K2_exh3:
	v_add_u32 v251, 32704, v230
	v_add_u32 v252, 16352, v231
	s_mov_b32 s40, -2
	s_branch K2_go3
K2_sw4:
	v_readfirstlane_b32 s24, v250
	s_nop 0
	s_add_u32 s24, s24, 8
	s_cmp_ge_u32 s24, 49
	s_cbranch_scc1 K2_exh4
	s_mov_b32 s23, s24
	v_readlane_b32 s21, v249, s24
	v_readlane_b32 s31, v232, s24
	s_mov_b64 exec, 1
	ds_add_rtn_u32 v250, v246, v247
	s_mov_b64 exec, -1
	s_add_u32 s22, s21, s31
	s_lshl_b32 s28, s21, 6
	s_lshr_b32 s29, s28, 1
	v_add_u32 v251, s28, v230
	v_add_u32 v252, s29, v231
	s_nop 0
	s_branch K2_have4
K2_exh4:
	v_add_u32 v251, 32704, v230
	v_add_u32 v252, 16352, v231
	s_mov_b32 s41, -2
	s_branch K2_go4
K2_slow:
	s_mov_b64 exec, -1
	s_load_dwordx2 s[48:49], s[0:1], 40
	s_load_dwordx2 s[52:53], s[0:1], 48
	s_load_dwordx2 s[56:57], s[0:1], 56
	v_lshlrev_b32 v60, 1, v246
	v_lshlrev_b32 v63, 2, v246
	v_mov_b32 v61, 0
	s_mov_b32 s82, 0xffff0000
	s_mul_i32 s79, s20, 5760
	s_add_u32 s79, s79, 94208
	v_add_u32 v62, s79, v63
	s_waitcnt lgkmcnt(0)
	s_and_b32 s49, s49, 0xffff
	s_mov_b32 s50, 10240
	s_mov_b32 s51, 0x20000
	s_and_b32 s53, s53, 0xffff
	s_mov_b32 s54, 16384
	s_mov_b32 s55, 0x20000
	s_and_b32 s57, s57, 0xffff
	s_mov_b32 s58, 24576
	s_mov_b32 s59, 0x20000
	s_mov_b32 s80, 0
	buffer_load_ushort v100, v60, s[48:51], s80 offen
	s_mov_b32 s80, 640
	buffer_load_ushort v101, v60, s[48:51], s80 offen
	s_mov_b32 s80, 1280
	buffer_load_ushort v102, v60, s[48:51], s80 offen
	s_mov_b32 s80, 1920
	buffer_load_ushort v103, v60, s[48:51], s80 offen
	s_mov_b32 s80, 2560
	buffer_load_ushort v104, v60, s[48:51], s80 offen
	s_mov_b32 s80, 3200
	buffer_load_ushort v105, v60, s[48:51], s80 offen
	s_mov_b32 s80, 3840
	buffer_load_ushort v106, v60, s[48:51], s80 offen
	s_mov_b32 s80, 4480
	buffer_load_ushort v107, v60, s[48:51], s80 offen
	s_mov_b32 s80, 5120
	buffer_load_ushort v108, v60, s[48:51], s80 offen
	s_mov_b32 s80, 5760
	buffer_load_ushort v109, v60, s[48:51], s80 offen
	s_mov_b32 s80, 6400
	buffer_load_ushort v110, v60, s[48:51], s80 offen
	s_mov_b32 s80, 7040
	buffer_load_ushort v111, v60, s[48:51], s80 offen
	s_mov_b32 s80, 7680
	buffer_load_ushort v112, v60, s[48:51], s80 offen
	s_mov_b32 s80, 8320
	buffer_load_ushort v113, v60, s[48:51], s80 offen
	s_mov_b32 s80, 8960
	buffer_load_ushort v114, v60, s[48:51], s80 offen
	s_mov_b32 s80, 9600
	buffer_load_ushort v115, v60, s[48:51], s80 offen
	s_waitcnt vmcnt(0)
	v_lshlrev_b32 v100, 16, v100
	v_lshlrev_b32 v101, 16, v101
	v_lshlrev_b32 v102, 16, v102
	v_lshlrev_b32 v103, 16, v103
	v_lshlrev_b32 v104, 16, v104
	v_lshlrev_b32 v105, 16, v105
	v_lshlrev_b32 v106, 16, v106
	v_lshlrev_b32 v107, 16, v107
	v_lshlrev_b32 v108, 16, v108
	v_lshlrev_b32 v109, 16, v109
	v_lshlrev_b32 v110, 16, v110
	v_lshlrev_b32 v111, 16, v111
	v_lshlrev_b32 v112, 16, v112
	v_lshlrev_b32 v113, 16, v113
	v_lshlrev_b32 v114, 16, v114
	v_lshlrev_b32 v115, 16, v115
	s_mov_b32 s80, 128
	buffer_load_ushort v116, v60, s[48:51], s80 offen
	s_mov_b32 s80, 768
	buffer_load_ushort v117, v60, s[48:51], s80 offen
	s_mov_b32 s80, 1408
	buffer_load_ushort v118, v60, s[48:51], s80 offen
	s_mov_b32 s80, 2048
	buffer_load_ushort v119, v60, s[48:51], s80 offen
	s_mov_b32 s80, 2688
	buffer_load_ushort v120, v60, s[48:51], s80 offen
	s_mov_b32 s80, 3328
	buffer_load_ushort v121, v60, s[48:51], s80 offen
	s_mov_b32 s80, 3968
	buffer_load_ushort v122, v60, s[48:51], s80 offen
	s_mov_b32 s80, 4608
	buffer_load_ushort v123, v60, s[48:51], s80 offen
	s_mov_b32 s80, 5248
	buffer_load_ushort v124, v60, s[48:51], s80 offen
	s_mov_b32 s80, 5888
	buffer_load_ushort v125, v60, s[48:51], s80 offen
	s_mov_b32 s80, 6528
	buffer_load_ushort v126, v60, s[48:51], s80 offen
	s_mov_b32 s80, 7168
	buffer_load_ushort v127, v60, s[48:51], s80 offen
	s_mov_b32 s80, 7808
	buffer_load_ushort v128, v60, s[48:51], s80 offen
	s_mov_b32 s80, 8448
	buffer_load_ushort v129, v60, s[48:51], s80 offen
	s_mov_b32 s80, 9088
	buffer_load_ushort v130, v60, s[48:51], s80 offen
	s_mov_b32 s80, 9728
	buffer_load_ushort v131, v60, s[48:51], s80 offen
	s_waitcnt vmcnt(0)
	v_lshlrev_b32 v116, 16, v116
	v_lshlrev_b32 v117, 16, v117
	v_lshlrev_b32 v118, 16, v118
	v_lshlrev_b32 v119, 16, v119
	v_lshlrev_b32 v120, 16, v120
	v_lshlrev_b32 v121, 16, v121
	v_lshlrev_b32 v122, 16, v122
	v_lshlrev_b32 v123, 16, v123
	v_lshlrev_b32 v124, 16, v124
	v_lshlrev_b32 v125, 16, v125
	v_lshlrev_b32 v126, 16, v126
	v_lshlrev_b32 v127, 16, v127
	v_lshlrev_b32 v128, 16, v128
	v_lshlrev_b32 v129, 16, v129
	v_lshlrev_b32 v130, 16, v130
	v_lshlrev_b32 v131, 16, v131
	s_mov_b32 s80, 256
	buffer_load_ushort v132, v60, s[48:51], s80 offen
	s_mov_b32 s80, 896
	buffer_load_ushort v133, v60, s[48:51], s80 offen
	s_mov_b32 s80, 1536
	buffer_load_ushort v134, v60, s[48:51], s80 offen
	s_mov_b32 s80, 2176
	buffer_load_ushort v135, v60, s[48:51], s80 offen
	s_mov_b32 s80, 2816
	buffer_load_ushort v136, v60, s[48:51], s80 offen
	s_mov_b32 s80, 3456
	buffer_load_ushort v137, v60, s[48:51], s80 offen
	s_mov_b32 s80, 4096
	buffer_load_ushort v138, v60, s[48:51], s80 offen
	s_mov_b32 s80, 4736
	buffer_load_ushort v139, v60, s[48:51], s80 offen
	s_mov_b32 s80, 5376
	buffer_load_ushort v140, v60, s[48:51], s80 offen
	s_mov_b32 s80, 6016
	buffer_load_ushort v141, v60, s[48:51], s80 offen
	s_mov_b32 s80, 6656
	buffer_load_ushort v142, v60, s[48:51], s80 offen
	s_mov_b32 s80, 7296
	buffer_load_ushort v143, v60, s[48:51], s80 offen
	s_mov_b32 s80, 7936
	buffer_load_ushort v144, v60, s[48:51], s80 offen
	s_mov_b32 s80, 8576
	buffer_load_ushort v145, v60, s[48:51], s80 offen
	s_mov_b32 s80, 9216
	buffer_load_ushort v146, v60, s[48:51], s80 offen
	s_mov_b32 s80, 9856
	buffer_load_ushort v147, v60, s[48:51], s80 offen
	s_waitcnt vmcnt(0)
	v_lshlrev_b32 v132, 16, v132
	v_lshlrev_b32 v133, 16, v133
	v_lshlrev_b32 v134, 16, v134
	v_lshlrev_b32 v135, 16, v135
	v_lshlrev_b32 v136, 16, v136
	v_lshlrev_b32 v137, 16, v137
	v_lshlrev_b32 v138, 16, v138
	v_lshlrev_b32 v139, 16, v139
	v_lshlrev_b32 v140, 16, v140
	v_lshlrev_b32 v141, 16, v141
	v_lshlrev_b32 v142, 16, v142
	v_lshlrev_b32 v143, 16, v143
	v_lshlrev_b32 v144, 16, v144
	v_lshlrev_b32 v145, 16, v145
	v_lshlrev_b32 v146, 16, v146
	v_lshlrev_b32 v147, 16, v147
	s_mov_b32 s80, 384
	buffer_load_ushort v148, v60, s[48:51], s80 offen
	s_mov_b32 s80, 1024
	buffer_load_ushort v149, v60, s[48:51], s80 offen
	s_mov_b32 s80, 1664
	buffer_load_ushort v150, v60, s[48:51], s80 offen
	s_mov_b32 s80, 2304
	buffer_load_ushort v151, v60, s[48:51], s80 offen
	s_mov_b32 s80, 2944
	buffer_load_ushort v152, v60, s[48:51], s80 offen
	s_mov_b32 s80, 3584
	buffer_load_ushort v153, v60, s[48:51], s80 offen
	s_mov_b32 s80, 4224
	buffer_load_ushort v154, v60, s[48:51], s80 offen
	s_mov_b32 s80, 4864
	buffer_load_ushort v155, v60, s[48:51], s80 offen
	s_mov_b32 s80, 5504
	buffer_load_ushort v156, v60, s[48:51], s80 offen
	s_mov_b32 s80, 6144
	buffer_load_ushort v157, v60, s[48:51], s80 offen
	s_mov_b32 s80, 6784
	buffer_load_ushort v158, v60, s[48:51], s80 offen
	s_mov_b32 s80, 7424
	buffer_load_ushort v159, v60, s[48:51], s80 offen
	s_mov_b32 s80, 8064
	buffer_load_ushort v160, v60, s[48:51], s80 offen
	s_mov_b32 s80, 8704
	buffer_load_ushort v161, v60, s[48:51], s80 offen
	s_mov_b32 s80, 9344
	buffer_load_ushort v162, v60, s[48:51], s80 offen
	s_mov_b32 s80, 9984
	buffer_load_ushort v163, v60, s[48:51], s80 offen
	s_waitcnt vmcnt(0)
	v_lshlrev_b32 v148, 16, v148
	v_lshlrev_b32 v149, 16, v149
	v_lshlrev_b32 v150, 16, v150
	v_lshlrev_b32 v151, 16, v151
	v_lshlrev_b32 v152, 16, v152
	v_lshlrev_b32 v153, 16, v153
	v_lshlrev_b32 v154, 16, v154
	v_lshlrev_b32 v155, 16, v155
	v_lshlrev_b32 v156, 16, v156
	v_lshlrev_b32 v157, 16, v157
	v_lshlrev_b32 v158, 16, v158
	v_lshlrev_b32 v159, 16, v159
	v_lshlrev_b32 v160, 16, v160
	v_lshlrev_b32 v161, 16, v161
	v_lshlrev_b32 v162, 16, v162
	v_lshlrev_b32 v163, 16, v163
	s_mov_b32 s80, 512
	buffer_load_ushort v164, v60, s[48:51], s80 offen
	s_mov_b32 s80, 1152
	buffer_load_ushort v165, v60, s[48:51], s80 offen
	s_mov_b32 s80, 1792
	buffer_load_ushort v166, v60, s[48:51], s80 offen
	s_mov_b32 s80, 2432
	buffer_load_ushort v167, v60, s[48:51], s80 offen
	s_mov_b32 s80, 3072
	buffer_load_ushort v168, v60, s[48:51], s80 offen
	s_mov_b32 s80, 3712
	buffer_load_ushort v169, v60, s[48:51], s80 offen
	s_mov_b32 s80, 4352
	buffer_load_ushort v170, v60, s[48:51], s80 offen
	s_mov_b32 s80, 4992
	buffer_load_ushort v171, v60, s[48:51], s80 offen
	s_mov_b32 s80, 5632
	buffer_load_ushort v172, v60, s[48:51], s80 offen
	s_mov_b32 s80, 6272
	buffer_load_ushort v173, v60, s[48:51], s80 offen
	s_mov_b32 s80, 6912
	buffer_load_ushort v174, v60, s[48:51], s80 offen
	s_mov_b32 s80, 7552
	buffer_load_ushort v175, v60, s[48:51], s80 offen
	s_mov_b32 s80, 8192
	buffer_load_ushort v176, v60, s[48:51], s80 offen
	s_mov_b32 s80, 8832
	buffer_load_ushort v177, v60, s[48:51], s80 offen
	s_mov_b32 s80, 9472
	buffer_load_ushort v178, v60, s[48:51], s80 offen
	s_mov_b32 s80, 10112
	buffer_load_ushort v179, v60, s[48:51], s80 offen
	s_waitcnt vmcnt(0)
	v_lshlrev_b32 v164, 16, v164
	v_lshlrev_b32 v165, 16, v165
	v_lshlrev_b32 v166, 16, v166
	v_lshlrev_b32 v167, 16, v167
	v_lshlrev_b32 v168, 16, v168
	v_lshlrev_b32 v169, 16, v169
	v_lshlrev_b32 v170, 16, v170
	v_lshlrev_b32 v171, 16, v171
	v_lshlrev_b32 v172, 16, v172
	v_lshlrev_b32 v173, 16, v173
	v_lshlrev_b32 v174, 16, v174
	v_lshlrev_b32 v175, 16, v175
	v_lshlrev_b32 v176, 16, v176
	v_lshlrev_b32 v177, 16, v177
	v_lshlrev_b32 v178, 16, v178
	v_lshlrev_b32 v179, 16, v179
	v_add_u32 v46, 0, v246
	v_cmp_gt_u32 vcc, 224, v46
	v_lshlrev_b32 v47, 10, v46
	s_lshl_b32 s80, s2, 2
	s_add_u32 s80, s80, 9699328
	buffer_load_dword v48, v47, s[16:19], s80 offen
	s_waitcnt vmcnt(0)
	v_cndmask_b32 v48, 0, v48, vcc
	ds_write_b32 v62, v48 offset:3072
	v_add_u32 v46, 64, v246
	v_cmp_gt_u32 vcc, 224, v46
	v_lshlrev_b32 v47, 10, v46
	s_lshl_b32 s80, s2, 2
	s_add_u32 s80, s80, 9699328
	buffer_load_dword v48, v47, s[16:19], s80 offen
	s_waitcnt vmcnt(0)
	v_cndmask_b32 v48, 0, v48, vcc
	ds_write_b32 v62, v48 offset:3328
	v_add_u32 v46, 128, v246
	v_cmp_gt_u32 vcc, 224, v46
	v_lshlrev_b32 v47, 10, v46
	s_lshl_b32 s80, s2, 2
	s_add_u32 s80, s80, 9699328
	buffer_load_dword v48, v47, s[16:19], s80 offen
	s_waitcnt vmcnt(0)
	v_cndmask_b32 v48, 0, v48, vcc
	ds_write_b32 v62, v48 offset:3584
	v_add_u32 v46, 192, v246
	v_cmp_gt_u32 vcc, 224, v46
	v_lshlrev_b32 v47, 10, v46
	s_lshl_b32 s80, s2, 2
	s_add_u32 s80, s80, 9699328
	buffer_load_dword v48, v47, s[16:19], s80 offen
	s_waitcnt vmcnt(0)
	v_cndmask_b32 v48, 0, v48, vcc
	ds_write_b32 v62, v48 offset:3840
	s_mov_b32 s60, s20
KS_node:
	s_cmp_ge_u32 s60, 196
	s_cbranch_scc1 K2_end
	s_mul_i32 s78, s2, 196
	s_add_u32 s78, s78, s60
	s_cmp_ge_u32 s78, 50000
	s_cbranch_scc1 K2_end
	s_lshl_b32 s78, s78, 9
	v_mov_b32 v0, 0
	v_mov_b32 v1, 0
	v_mov_b32 v2, 0
	v_mov_b32 v3, 0
	v_mov_b32 v4, 0
	v_mov_b32 v5, 0
	v_mov_b32 v6, 0
	v_mov_b32 v7, 0
	v_mov_b32 v8, 0
	v_mov_b32 v9, 0
	v_mov_b32 v10, 0
	s_mov_b32 s61, 0
KS_chunk:
	s_lshl_b32 s80, s61, 2
	s_add_u32 s80, s80, s79
	v_mov_b32 v46, s80
	ds_read_b32 v47, v46 offset:3072
	s_waitcnt lgkmcnt(0)
	v_readfirstlane_b32 s80, v47
	s_nop 0
	s_and_b32 s63, s80, 0xffff
	s_lshr_b32 s62, s80, 16
	s_mul_i32 s80, s61, 3584
	s_add_u32 s63, s63, s80
	s_mov_b32 s64, 0
KS_batch:
	s_cmp_ge_u32 s64, s62
	s_cbranch_scc1 KS_chunk_next
	v_add_u32 v46, s64, v246
	v_cmp_gt_u32 vcc, s62, v46
	v_add_u32 v46, s63, v46
	v_mul_u32_u24 v46, 12, v46
	v_mov_b32 v47, 2.0
	v_cndmask_b32 v46, v47, v46, vcc
	s_mov_b64 s[66:67], vcc
	buffer_load_dwordx3 v[56:58], v46, s[16:19], 0 offen
	s_waitcnt vmcnt(0)
	v_lshrrev_b32 v46, 24, v58
	v_cmp_eq_u32 vcc, s60, v46
	s_nop 0
	s_and_b64 s[66:67], s[66:67], vcc
KS_edge:
	s_cmp_eq_u64 s[66:67], 0
	s_cbranch_scc1 KS_batch_next
	s_ff1_i32_b64 s68, s[66:67]
	s_bitset0_b64 s[66:67], s68
	v_readlane_b32 s69, v56, s68
	v_readlane_b32 s70, v57, s68
	v_readlane_b32 s71, v58, s68
	s_and_b32 s75, s69, 0xffff
	s_lshl_b32 s75, s75, 9
	s_and_b32 s76, s71, 0xffffff
	s_lshl_b32 s76, s76, 5
	s_and_b32 s72, s69, s82
	s_lshl_b32 s73, s70, 16
	s_and_b32 s74, s70, s82
	buffer_load_ushort v12, v60, s[4:7], s75 offen offset:0
	buffer_load_ushort v13, v60, s[4:7], s75 offen offset:128
	buffer_load_ushort v14, v60, s[4:7], s75 offen offset:256
	buffer_load_ushort v15, v60, s[4:7], s75 offen offset:384
	buffer_load_dwordx4 v[16:19], v61, s[8:11], s76 offen
	buffer_load_dwordx4 v[20:23], v61, s[8:11], s76 offen offset:16
	s_waitcnt vmcnt(0)
	v_lshlrev_b32 v12, 16, v12
	v_lshlrev_b32 v13, 16, v13
	v_lshlrev_b32 v14, 16, v14
	v_lshlrev_b32 v15, 16, v15
	v_lshlrev_b32 v24, 16, v16
	v_and_b32 v25, s82, v16
	v_lshlrev_b32 v26, 16, v17
	v_and_b32 v27, s82, v17
	v_lshlrev_b32 v28, 16, v18
	v_and_b32 v29, s82, v18
	v_lshlrev_b32 v30, 16, v19
	v_and_b32 v31, s82, v19
	v_lshlrev_b32 v32, 16, v20
	v_and_b32 v33, s82, v20
	v_lshlrev_b32 v34, 16, v21
	v_and_b32 v35, s82, v21
	v_lshlrev_b32 v36, 16, v22
	v_and_b32 v37, s82, v22
	v_lshlrev_b32 v38, 16, v23
	v_and_b32 v39, s82, v23
	v_mul_f32 v40, v24, v100
	v_fmac_f32 v40, v25, v101
	v_fmac_f32 v40, v26, v102
	v_fmac_f32 v40, v27, v103
	v_fmac_f32 v40, v28, v104
	v_fmac_f32 v40, v29, v105
	v_fmac_f32 v40, v30, v106
	v_fmac_f32 v40, v31, v107
	v_fmac_f32 v40, v32, v108
	v_fmac_f32 v40, v33, v109
	v_fmac_f32 v40, v34, v110
	v_fmac_f32 v40, v35, v111
	v_fmac_f32 v40, v36, v112
	v_fmac_f32 v40, v37, v113
	v_fmac_f32 v40, v38, v114
	v_fmac_f32 v40, v39, v115
	v_mul_f32 v41, v24, v116
	v_fmac_f32 v41, v25, v117
	v_fmac_f32 v41, v26, v118
	v_fmac_f32 v41, v27, v119
	v_fmac_f32 v41, v28, v120
	v_fmac_f32 v41, v29, v121
	v_fmac_f32 v41, v30, v122
	v_fmac_f32 v41, v31, v123
	v_fmac_f32 v41, v32, v124
	v_fmac_f32 v41, v33, v125
	v_fmac_f32 v41, v34, v126
	v_fmac_f32 v41, v35, v127
	v_fmac_f32 v41, v36, v128
	v_fmac_f32 v41, v37, v129
	v_fmac_f32 v41, v38, v130
	v_fmac_f32 v41, v39, v131
	v_mul_f32 v42, v24, v132
	v_fmac_f32 v42, v25, v133
	v_fmac_f32 v42, v26, v134
	v_fmac_f32 v42, v27, v135
	v_fmac_f32 v42, v28, v136
	v_fmac_f32 v42, v29, v137
	v_fmac_f32 v42, v30, v138
	v_fmac_f32 v42, v31, v139
	v_fmac_f32 v42, v32, v140
	v_fmac_f32 v42, v33, v141
	v_fmac_f32 v42, v34, v142
	v_fmac_f32 v42, v35, v143
	v_fmac_f32 v42, v36, v144
	v_fmac_f32 v42, v37, v145
	v_fmac_f32 v42, v38, v146
	v_fmac_f32 v42, v39, v147
	v_mul_f32 v43, v24, v148
	v_fmac_f32 v43, v25, v149
	v_fmac_f32 v43, v26, v150
	v_fmac_f32 v43, v27, v151
	v_fmac_f32 v43, v28, v152
	v_fmac_f32 v43, v29, v153
	v_fmac_f32 v43, v30, v154
	v_fmac_f32 v43, v31, v155
	v_fmac_f32 v43, v32, v156
	v_fmac_f32 v43, v33, v157
	v_fmac_f32 v43, v34, v158
	v_fmac_f32 v43, v35, v159
	v_fmac_f32 v43, v36, v160
	v_fmac_f32 v43, v37, v161
	v_fmac_f32 v43, v38, v162
	v_fmac_f32 v43, v39, v163
	v_mul_f32 v44, v24, v164
	v_fmac_f32 v44, v25, v165
	v_fmac_f32 v44, v26, v166
	v_fmac_f32 v44, v27, v167
	v_fmac_f32 v44, v28, v168
	v_fmac_f32 v44, v29, v169
	v_fmac_f32 v44, v30, v170
	v_fmac_f32 v44, v31, v171
	v_fmac_f32 v44, v32, v172
	v_fmac_f32 v44, v33, v173
	v_fmac_f32 v44, v34, v174
	v_fmac_f32 v44, v35, v175
	v_fmac_f32 v44, v36, v176
	v_fmac_f32 v44, v37, v177
	v_fmac_f32 v44, v38, v178
	v_fmac_f32 v44, v39, v179
	v_fmac_f32 v0, v12, v40
	v_mul_f32 v46, s72, v13
	v_fmac_f32 v46, s73, v14
	v_fmac_f32 v46, s74, v15
	v_fmac_f32 v1, v46, v41
	v_mul_f32 v46, v12, v42
	v_fmac_f32 v2, s72, v46
	v_fmac_f32 v3, s73, v46
	v_fmac_f32 v4, s74, v46
	v_fmac_f32 v5, v13, v43
	v_fmac_f32 v6, v14, v43
	v_fmac_f32 v7, v15, v43
	v_mul_f32 v47, v13, v44
	v_mul_f32 v48, v14, v44
	v_mul_f32 v49, v15, v44
	v_fmac_f32 v8, s73, v49
	v_fma_f32 v8, -s74, v48, v8
	v_fmac_f32 v9, s74, v47
	v_fma_f32 v9, -s72, v49, v9
	v_fmac_f32 v10, s72, v48
	v_fma_f32 v10, -s73, v47, v10
	s_nop 0
	s_branch KS_edge
KS_batch_next:
	s_add_u32 s64, s64, 64
	s_branch KS_batch
KS_chunk_next:
	s_add_u32 s61, s61, 1
	s_cmp_lt_u32 s61, 224
	s_cbranch_scc1 KS_chunk
	ds_write_b32 v62, v0 offset:0
	ds_write_b32 v62, v1 offset:256
	ds_write_b32 v62, v2 offset:512
	ds_write_b32 v62, v3 offset:768
	ds_write_b32 v62, v4 offset:1024
	ds_write_b32 v62, v5 offset:1280
	ds_write_b32 v62, v6 offset:1536
	ds_write_b32 v62, v7 offset:1792
	ds_write_b32 v62, v8 offset:2048
	ds_write_b32 v62, v9 offset:2304
	ds_write_b32 v62, v10 offset:2560
	v_mov_b32 v64, 0
	v_mov_b32 v65, 0
	v_mov_b32 v66, 0
	v_mov_b32 v67, 0
	s_mov_b32 s77, 0
KS_g0:
	s_lshl_b32 s80, s77, 2
	s_add_u32 s80, s80, s79
	v_mov_b32 v46, s80
	s_lshl_b32 s81, s77, 7
	ds_read_b32 v24, v46 offset:0
	buffer_load_ushort v32, v60, s[52:55], s81 offen offset:0
	ds_read_b32 v25, v46 offset:4
	buffer_load_ushort v33, v60, s[52:55], s81 offen offset:128
	ds_read_b32 v26, v46 offset:8
	buffer_load_ushort v34, v60, s[52:55], s81 offen offset:256
	ds_read_b32 v27, v46 offset:12
	buffer_load_ushort v35, v60, s[52:55], s81 offen offset:384
	ds_read_b32 v28, v46 offset:16
	buffer_load_ushort v36, v60, s[52:55], s81 offen offset:512
	ds_read_b32 v29, v46 offset:20
	buffer_load_ushort v37, v60, s[52:55], s81 offen offset:640
	ds_read_b32 v30, v46 offset:24
	buffer_load_ushort v38, v60, s[52:55], s81 offen offset:768
	ds_read_b32 v31, v46 offset:28
	buffer_load_ushort v39, v60, s[52:55], s81 offen offset:896
	s_waitcnt vmcnt(0) lgkmcnt(0)
	v_lshlrev_b32 v32, 16, v32
	v_fmac_f32 v64, v24, v32
	v_lshlrev_b32 v33, 16, v33
	v_fmac_f32 v64, v25, v33
	v_lshlrev_b32 v34, 16, v34
	v_fmac_f32 v64, v26, v34
	v_lshlrev_b32 v35, 16, v35
	v_fmac_f32 v64, v27, v35
	v_lshlrev_b32 v36, 16, v36
	v_fmac_f32 v64, v28, v36
	v_lshlrev_b32 v37, 16, v37
	v_fmac_f32 v64, v29, v37
	v_lshlrev_b32 v38, 16, v38
	v_fmac_f32 v64, v30, v38
	v_lshlrev_b32 v39, 16, v39
	v_fmac_f32 v64, v31, v39
	s_add_u32 s77, s77, 8
	s_cmp_lt_u32 s77, 128
	s_cbranch_scc1 KS_g0
	s_mov_b32 s77, 0
KS_g1:
	s_lshr_b32 s80, s77, 6
	s_mul_i32 s80, s80, 768
	s_and_b32 s81, s77, 63
	s_lshl_b32 s81, s81, 2
	s_add_u32 s80, s80, s81
	s_add_u32 s80, s80, s79
	v_mov_b32 v46, s80
	s_lshl_b32 s81, s77, 7
	ds_read_b32 v24, v46 offset:512
	ds_read_b32 v25, v46 offset:768
	ds_read_b32 v26, v46 offset:1024
	buffer_load_ushort v36, v60, s[56:59], s81 offen offset:0
	ds_read_b32 v27, v46 offset:516
	ds_read_b32 v28, v46 offset:772
	ds_read_b32 v29, v46 offset:1028
	buffer_load_ushort v37, v60, s[56:59], s81 offen offset:128
	ds_read_b32 v30, v46 offset:520
	ds_read_b32 v31, v46 offset:776
	ds_read_b32 v32, v46 offset:1032
	buffer_load_ushort v38, v60, s[56:59], s81 offen offset:256
	ds_read_b32 v33, v46 offset:524
	ds_read_b32 v34, v46 offset:780
	ds_read_b32 v35, v46 offset:1036
	buffer_load_ushort v39, v60, s[56:59], s81 offen offset:384
	s_waitcnt vmcnt(0) lgkmcnt(0)
	v_lshlrev_b32 v36, 16, v36
	v_fmac_f32 v65, v24, v36
	v_fmac_f32 v66, v25, v36
	v_fmac_f32 v67, v26, v36
	v_lshlrev_b32 v37, 16, v37
	v_fmac_f32 v65, v27, v37
	v_fmac_f32 v66, v28, v37
	v_fmac_f32 v67, v29, v37
	v_lshlrev_b32 v38, 16, v38
	v_fmac_f32 v65, v30, v38
	v_fmac_f32 v66, v31, v38
	v_fmac_f32 v67, v32, v38
	v_lshlrev_b32 v39, 16, v39
	v_fmac_f32 v65, v33, v39
	v_fmac_f32 v66, v34, v39
	v_fmac_f32 v67, v35, v39
	s_add_u32 s77, s77, 4
	s_cmp_lt_u32 s77, 192
	s_cbranch_scc1 KS_g1
	v_mul_f32 v46, 0xbfb8aa3b, v64
	v_exp_f32 v46, v46
	s_nop 0
	v_add_f32 v46, 1.0, v46
	v_rcp_f32 v46, v46
	s_nop 0
	v_mul_f32 v65, v46, v65
	v_mul_f32 v66, v46, v66
	v_mul_f32 v67, v46, v67
	v_cvt_pk_bf16_f32 v64, v64, v64
	buffer_store_short v64, v60, s[12:15], s78 offen offset:0
	v_cvt_pk_bf16_f32 v65, v65, v65
	buffer_store_short v65, v60, s[12:15], s78 offen offset:128
	v_cvt_pk_bf16_f32 v66, v66, v66
	buffer_store_short v66, v60, s[12:15], s78 offen offset:256
	v_cvt_pk_bf16_f32 v67, v67, v67
	buffer_store_short v67, v60, s[12:15], s78 offen offset:384
	s_add_u32 s60, s60, 8
	s_branch KS_node
K2_end:
	s_endpgm
.section .rodata,"a"
.p2align 6
.amdhsa_kernel k1_sort_kernel
  .amdhsa_next_free_vgpr 72
  .amdhsa_next_free_sgpr 48
  .amdhsa_accum_offset 72
  .amdhsa_group_segment_fixed_size 0
  .amdhsa_kernarg_size 96
  .amdhsa_user_sgpr_count 2
  .amdhsa_user_sgpr_kernarg_segment_ptr 1
  .amdhsa_system_sgpr_workgroup_id_x 1
.end_amdhsa_kernel
.p2align 6
.amdhsa_kernel gather_scatter__tensor_product_equiv_equiformer__graph_kernel
  .amdhsa_next_free_vgpr 256
  .amdhsa_next_free_sgpr 102
  .amdhsa_accum_offset 256
  .amdhsa_group_segment_fixed_size 0
  .amdhsa_kernarg_size 96
  .amdhsa_user_sgpr_count 2
  .amdhsa_user_sgpr_kernarg_segment_ptr 1
  .amdhsa_system_sgpr_workgroup_id_x 1
.end_amdhsa_kernel
```
